```python
import torch

def _softmax(x, axis=-1):
    return torch.softmax(x, dim=axis)
def _gelu(x):
    return torch.nn.functional.gelu(x, approximate="tanh")
def _silu(x):
    return torch.nn.functional.silu(x)
def _sigmoid(x):
    return torch.sigmoid(x)
def _layernorm(x, axis=-1, eps=1e-5):
    m = x.mean(dim=axis, keepdim=True)
    v = x.var(dim=axis, keepdim=True, unbiased=False)
    return (x - m) / torch.sqrt(v + eps)
def _scatter_add(tgt, idx, src, axis=0):
    return tgt.clone().index_add_(axis, idx, src)
def _segment_sum(src, seg, n):
    out = torch.zeros((n,) + src.shape[1:], dtype=src.dtype)
    return out.index_add_(0, seg, src)
def _pad(x, pw):
    flat = tuple(v for pair in reversed(pw) for v in pair)
    return torch.nn.functional.pad(x, flat)

kernel_name = 'standalone__detection_seg_mask2former__vision'

def setup_inputs():

    _w = (lambda a: (lambda t: t.to(torch.bfloat16) if t.is_floating_point() else t)(torch.as_tensor(a)))
    H = W = 512
    C = 192
    Hc, Wc = H // 2, W // 2
    nh = 4
    Nq = 16
    sc = C ** -0.5
    return {
        "q": _w((lambda *s: torch.randn(*s, dtype=torch.bfloat16) * 0.4)(1, Nq, C)),
        "f_hi": _w((lambda *s: torch.randn(*s, dtype=torch.bfloat16) * 0.4)(1, H, W, C)),
        "f_lo": _w((lambda *s: torch.randn(*s, dtype=torch.bfloat16) * 0.4)(1, Hc, Wc, C)),
        "w_lat": _w((lambda *s: torch.randn(*s, dtype=torch.bfloat16) * 0.4)(C, C) * sc),
        "w_q": _w((lambda *s: torch.randn(*s, dtype=torch.bfloat16) * 3.2)(nh, C, C // nh) * sc),
        "w_k": _w((lambda *s: torch.randn(*s, dtype=torch.bfloat16) * 3.2)(nh, C, C // nh) * sc),
        "w_v": _w((lambda *s: torch.randn(*s, dtype=torch.bfloat16) * 3.2)(nh, C, C // nh) * sc),
        "w_o": _w((lambda *s: torch.randn(*s, dtype=torch.bfloat16) * 3.2)(C, C) * sc),
        "w_m": _w((lambda *s: torch.randn(*s, dtype=torch.bfloat16) * 3.2)(C, C) * sc),
    }

def reference(q, f_hi, f_lo, w_lat, w_q, w_k, w_v, w_o, w_m):
    B, Nq, C = q.shape
    _, H, W, _ = f_hi.shape
    nh = w_q.shape[0]
    dh = C // nh
    up = (lambda x, n, axis: torch.repeat_interleave(x, n, dim=axis))((lambda x, n, axis: torch.repeat_interleave(x, n, dim=axis))(f_lo, 2, axis=1), 2, axis=2)
    feat = f_hi + up @ w_lat
    feat = _layernorm(feat, axis=-1)
    kv = feat.reshape(B, H * W, C)
    m_embed = q @ w_m
    mask_bias = torch.einsum('bqc,bkc->bqk', m_embed, kv) * (C ** -0.5)
    Q = torch.einsum('bqc,hcd->bhqd', q, w_q)
    K = torch.einsum('bkc,hcd->bhkd', kv, w_k)
    V = torch.einsum('bkc,hcd->bhkd', kv, w_v)
    logits = torch.einsum('bhqd,bhkd->bhqk', Q, K) * (dh ** -0.5)
    logits = logits + mask_bias[:, None, :, :]
    attn = _softmax(logits, axis=-1)
    ctx = torch.einsum('bhqk,bhkd->bqhd', attn, V).reshape(B, Nq, C)
    return q + ctx @ w_o
```

```asm
; @launch grid=(256,1,1) block=(512,1,1) lds=158912
.amdgcn_target "amdgcn-amd-amdhsa--gfx950"
.text
.globl standalone__detection_seg_mask2former__vision_kernel
.p2align 8
.type standalone__detection_seg_mask2former__vision_kernel,@function
standalone__detection_seg_mask2former__vision_kernel:
s_cmp_ge_u32 s2, 256
s_cbranch_scc1 M_end
s_load_dwordx16 s[48:63], s[0:1], 0
s_load_dwordx8 s[64:71], s[0:1], 64
s_getpc_b64 s[10:11]
M_pc:
v_lshlrev_b32 v2, 7, v0
v_min_u32 v2, M_end-M_pc, v2
v_mov_b32 v3, s11
v_add_co_u32 v2, vcc, s10, v2
v_addc_co_u32 v3, vcc, 0, v3, vcc
global_load_dword v254, v[2:3], off
v_lshrrev_b32 v1, 6, v0
v_and_b32 v0, 63, v0
v_readfirstlane_b32 s24, v1
v_lshlrev_b32 v14, 2, v1
v_add_u32 v14, 158720, v14
v_mov_b32 v15, 0
ds_write2_b32 v14, v15, v15 offset0:8 offset1:16
v_mov_b32 v16, 1
ds_write2_b32 v14, v15, v16 offset0:0 offset1:24
s_cmp_lt_u32 s24, 4
s_cbranch_scc1 M_prod
v_mov_b32 v246, v0
s_cmp_lt_u32 s2, 128
s_cbranch_scc0 C_plain
s_lshr_b32 s36, s2, 5
s_bfe_u32 s37, s2, 0x20003
s_cmp_eq_u32 s24, 7
s_cbranch_scc1 PR_issueQ
v_mul_u32_u24 v239, 43, v246
v_lshrrev_b32 v239, 8, v239
v_mul_u32_u24 v240, 6, v239
v_sub_u32 v238, v246, v240
v_mul_u32_u24 v239, 384, v239
v_lshl_add_u32 v235, v238, 4, v239
s_sub_u32 s38, s24, 4
s_mul_i32 s39, s37, 96
s_mul_i32 s40, s38, 24576
s_add_u32 s39, s39, s40
s_mul_i32 s40, s38, 6144
s_add_u32 s40, s40, 94464
s_add_u32 s41, s40, 6144
s_mov_b32 s42, -1
s_mov_b32 s43, 0xffff
s_waitcnt lgkmcnt(0)
s_mov_b32 s16, s64
s_mov_b32 s17, s65
s_mov_b32 s18, 73728
s_mov_b32 s19, 0x20000
s_mov_b64 exec, s[42:43]
PR_lm:
s_mov_b32 m0, s40
s_add_u32 s40, s40, 768
buffer_load_dwordx4 v235, s[16:19], s39 offen lds
s_add_u32 s39, s39, 3072
s_cmp_lt_u32 s40, s41
s_cbranch_scc1 PR_lm
s_lshl_b32 s6, s24, 2
s_add_u32 m0, s6, 158816
s_mov_b64 exec, 1
v_mov_b32 v236, 0x7ffffff0
buffer_load_dword v236, s[16:19], 0 offen lds
s_mov_b64 exec, -1
s_mov_b32 s16, s54
s_mov_b32 s17, s55
s_barrier
s_load_dword s7, s[70:71], 671744
v_add_u32 v14, 0, v0
v_mul_u32_u24 v14, 2731, v14
v_lshrrev_b32 v14, 12, v14
v_and_b32 v14, 32, v14
v_lshlrev_b32 v8, 4, v0
v_xor_b32 v8, v8, v14
v_xor_b32 v11, 64, v8
v_add_u32 v14, 64, v0
v_mul_u32_u24 v14, 2731, v14
v_lshrrev_b32 v14, 12, v14
v_and_b32 v14, 32, v14
v_lshlrev_b32 v9, 4, v0
v_xor_b32 v9, v9, v14
v_xor_b32 v12, 64, v9
v_add_u32 v14, 128, v0
v_mul_u32_u24 v14, 2731, v14
v_lshrrev_b32 v14, 12, v14
v_and_b32 v14, 32, v14
v_lshlrev_b32 v10, 4, v0
v_xor_b32 v10, v10, v14
v_xor_b32 v13, 64, v10
s_mul_i32 s34, s38, 24576
s_mov_b32 s35, 4
C_wla:
s_mov_b32 m0, s34
s_nop 0
buffer_load_dwordx4 v8, s[16:19], s34 offen offset:0 lds
buffer_load_dwordx4 v9, s[16:19], s34 offen offset:1024 lds
buffer_load_dwordx4 v10, s[16:19], s34 offen offset:2048 lds
s_add_u32 s34, s34, 3072
s_mov_b32 m0, s34
s_nop 0
buffer_load_dwordx4 v11, s[16:19], s34 offen offset:0 lds
buffer_load_dwordx4 v12, s[16:19], s34 offen offset:1024 lds
buffer_load_dwordx4 v13, s[16:19], s34 offen offset:2048 lds
s_add_u32 s34, s34, 3072
s_cmp_eq_u32 s34, 73728
s_cselect_b32 s34, 0, s34
s_sub_u32 s35, s35, 1
s_cmp_lg_u32 s35, 0
s_cbranch_scc1 C_wla
s_branch C_issb
PR_issueQ:
v_lshlrev_b32 v234, 4, v246
s_mul_i32 s38, s36, 18432
s_mul_i32 s39, s37, 4608
s_add_u32 s39, s38, s39
s_mov_b32 s42, -1
s_mov_b32 s43, 0xffff
s_mov_b32 m0, 119040
s_waitcnt lgkmcnt(0)
s_mov_b32 s16, s58
s_mov_b32 s17, s59
s_mov_b32 s18, 73728
s_mov_b32 s19, 0x20000
s_mov_b64 exec, s[42:43]
buffer_load_dwordx4 v234, s[16:19], s39 offen offset:0 lds
buffer_load_dwordx4 v234, s[16:19], s39 offen offset:768 lds
buffer_load_dwordx4 v234, s[16:19], s39 offen offset:1536 lds
buffer_load_dwordx4 v234, s[16:19], s39 offen offset:2304 lds
buffer_load_dwordx4 v234, s[16:19], s39 offen offset:3072 lds
buffer_load_dwordx4 v234, s[16:19], s39 offen offset:3840 lds
s_lshl_b32 s6, s24, 2
s_add_u32 m0, s6, 158816
s_mov_b64 exec, 1
v_mov_b32 v236, 0x7ffffff0
buffer_load_dword v236, s[16:19], 0 offen lds
s_mov_b64 exec, -1
s_barrier
s_load_dword s7, s[70:71], 671744
s_branch PR_compA
C_plain:
v_add_u32 v14, 0, v0
v_mul_u32_u24 v14, 2731, v14
v_lshrrev_b32 v14, 12, v14
v_and_b32 v14, 32, v14
v_lshlrev_b32 v8, 4, v0
v_xor_b32 v8, v8, v14
v_xor_b32 v11, 64, v8
v_add_u32 v14, 64, v0
v_mul_u32_u24 v14, 2731, v14
v_lshrrev_b32 v14, 12, v14
v_and_b32 v14, 32, v14
v_lshlrev_b32 v9, 4, v0
v_xor_b32 v9, v9, v14
v_xor_b32 v12, 64, v9
v_add_u32 v14, 128, v0
v_mul_u32_u24 v14, 2731, v14
v_lshrrev_b32 v14, 12, v14
v_and_b32 v14, 32, v14
v_lshlrev_b32 v10, 4, v0
v_xor_b32 v10, v10, v14
v_xor_b32 v13, 64, v10
s_lshr_b32 s34, s2, 3
s_and_b32 s34, s34, 3
s_mul_i32 s35, s24, 3
s_add_u32 s34, s34, s35
s_sub_u32 s34, s34, 12
s_cmp_ge_u32 s34, 12
s_cselect_b32 s35, 12, 0
s_sub_u32 s34, s34, s35
s_mul_i32 s34, s34, 6144
s_mov_b32 s35, 3
s_waitcnt lgkmcnt(0)
s_mov_b32 s16, s54
s_mov_b32 s17, s55
s_mov_b32 s18, 73728
s_mov_b32 s19, 0x20000
s_load_dword s7, s[70:71], 671744
C_wl:
s_mov_b32 m0, s34
s_nop 0
buffer_load_dwordx4 v8, s[16:19], s34 offen offset:0 lds
buffer_load_dwordx4 v9, s[16:19], s34 offen offset:1024 lds
buffer_load_dwordx4 v10, s[16:19], s34 offen offset:2048 lds
s_add_u32 s34, s34, 3072
s_mov_b32 m0, s34
s_nop 0
buffer_load_dwordx4 v11, s[16:19], s34 offen offset:0 lds
buffer_load_dwordx4 v12, s[16:19], s34 offen offset:1024 lds
buffer_load_dwordx4 v13, s[16:19], s34 offen offset:2048 lds
s_add_u32 s34, s34, 3072
s_cmp_eq_u32 s34, 73728
s_cselect_b32 s34, 0, s34
s_sub_u32 s35, s35, 1
s_cmp_lg_u32 s35, 0
s_cbranch_scc1 C_wl
s_sub_u32 s12, s2, 128
s_cmp_lt_u32 s12, 24
s_cselect_b32 s13, s24, 0
s_cmp_eq_u32 s13, 7
s_cbranch_scc1 PR_issueV
C_issb:
s_barrier
C_iss:
s_waitcnt vmcnt(0)
s_lshl_b32 s6, s24, 2
s_add_u32 s6, s6, 158752
v_mov_b32 v250, s6
v_mov_b32 v251, 1
ds_write_b32 v250, v251
s_waitcnt lgkmcnt(0)
s_mul_i32 s7, s7, 1664525
s_add_u32 s7, s7, 1013904223
s_or_b32 s7, s7, 1
s_branch C_pro2
M_prod:
v_mov_b32 v252, v0
s_mul_i32 s25, s2, 393216
s_mul_i32 s28, s24, 3072
s_add_u32 s26, s25, s28
v_lshrrev_b32 v248, 3, v252
v_and_b32 v249, 7, v252
v_mul_u32_u24 v234, 384, v248
v_lshl_add_u32 v234, v249, 4, v234
v_cmp_le_u32 vcc, 24, v252
v_subrev_u32 v250, 24, v252
s_lshl_b32 s28, s24, 2
s_and_b32 s28, s28, 4
v_cndmask_b32 v250, v252, v250, vcc
v_cndmask_b32 v251, 0, 1, vcc
v_xor_b32 v250, s28, v250
v_lshlrev_b32 v250, 4, v250
v_mul_u32_u24 v251, 384, v251
v_add_u32 v246, v250, v251
v_xor_b32 v247, 32, v246
s_mul_i32 s29, s2, 98304
s_mul_i32 s28, s24, 1536
s_add_u32 s29, s29, s28
s_add_u32 s33, s28, 125952
s_mov_b32 s42, -1
s_mov_b32 s43, 0xffff
s_waitcnt lgkmcnt(0)
s_load_dword s7, s[70:71], 671744
s_mov_b32 s12, s52
s_mov_b32 s13, s53
s_mov_b32 s14, 25165824
s_mov_b32 s15, 0x20000
s_movk_i32 s36, 384
s_cmp_lt_u32 s2, 128
s_cbranch_scc0 PP_noq
s_cmp_lt_u32 s24, 3
s_cbranch_scc0 PP_q3
s_mov_b32 s16, s56
s_mov_b32 s17, s57
s_mov_b32 s18, 73728
s_mov_b32 s19, 0x20000
v_lshlrev_b32 v14, 4, v252
s_lshr_b32 s36, s2, 5
s_mul_i32 s36, s36, 18432
s_mul_i32 s37, s24, 6144
s_add_u32 s36, s36, s37
s_add_u32 m0, s37, 76032
s_nop 0
buffer_load_dwordx4 v14, s[16:19], s36 offen offset:0 lds
buffer_load_dwordx4 v14, s[16:19], s36 offen offset:1024 lds
buffer_load_dwordx4 v14, s[16:19], s36 offen offset:2048 lds
s_add_u32 s36, s36, 3072
s_add_u32 m0, s37, 79104
s_nop 0
buffer_load_dwordx4 v14, s[16:19], s36 offen offset:0 lds
buffer_load_dwordx4 v14, s[16:19], s36 offen offset:1024 lds
buffer_load_dwordx4 v14, s[16:19], s36 offen offset:2048 lds
s_branch PP_q
PP_q3:
s_mov_b32 s16, s48
s_mov_b32 s17, s49
s_mov_b32 s18, 6144
s_mov_b32 s19, 0x20000
v_xor_b32 v14, v248, v249
v_lshlrev_b32 v14, 4, v14
v_mad_u32_u24 v14, v248, s36, v14
s_mov_b32 m0, 112896
s_movk_i32 s37, 0
buffer_load_dwordx4 v14, s[16:19], s37 offen lds
s_mov_b32 m0, 113920
s_movk_i32 s37, 3072
buffer_load_dwordx4 v14, s[16:19], s37 offen lds
s_mov_b32 m0, 114944
s_movk_i32 s37, 128
buffer_load_dwordx4 v14, s[16:19], s37 offen lds
s_mov_b32 m0, 115968
s_movk_i32 s37, 3200
buffer_load_dwordx4 v14, s[16:19], s37 offen lds
s_mov_b32 m0, 116992
s_movk_i32 s37, 256
buffer_load_dwordx4 v14, s[16:19], s37 offen lds
s_mov_b32 m0, 118016
s_movk_i32 s37, 3328
buffer_load_dwordx4 v14, s[16:19], s37 offen lds
PP_q:
s_lshl_b32 s6, s24, 2
s_add_u32 m0, s6, 158816
s_mov_b64 exec, 1
v_mov_b32 v14, 0x7ffffff0
buffer_load_dword v14, s[16:19], 0 offen lds
s_mov_b64 exec, -1
s_barrier
s_mov_b32 s8, s50
s_mov_b32 s9, s51
s_mov_b32 s10, 100663296
s_mov_b32 s11, 0x20000
PP_noq:
s_add_u32 m0, s33, 0
s_mov_b64 exec, s[42:43]
buffer_load_dwordx4 v246, s[12:15], s29 offen nt lds
buffer_load_dwordx4 v247, s[12:15], s29 offen offset:768 nt lds
s_mov_b64 exec, -1
s_add_u32 s29, s29, 6144
s_add_u32 m0, s33, 6144
s_mov_b64 exec, s[42:43]
buffer_load_dwordx4 v246, s[12:15], s29 offen nt lds
buffer_load_dwordx4 v247, s[12:15], s29 offen offset:768 nt lds
s_mov_b64 exec, -1
s_add_u32 s29, s29, 6144
s_mov_b32 s8, s50
s_mov_b32 s9, s51
s_mov_b32 s10, 100663296
s_mov_b32 s11, 0x20000
s_mov_b32 s20, s70
s_mov_b32 s21, s71
s_mov_b32 s22, 402653184
s_mov_b32 s23, 0x20000
s_and_b32 s3, s2, 7
s_lshl_b32 s3, s3, 5
s_lshr_b32 s4, s2, 3
s_add_u32 s3, s3, s4
s_sub_u32 s4, s2, 120
s_lshr_b32 s5, s4, 3
s_xor_b32 s6, s4, s5
s_and_b32 s6, s6, 7
s_cmp_eq_u32 s6, 0
s_cselect_b32 s5, s5, -1
s_cmp_lt_u32 s4, 128
s_cselect_b32 s5, s5, -1
v_and_b32 v250, 15, v252
v_lshrrev_b32 v251, 4, v252
v_and_b32 v235, 6, v250
v_xor_b32 v235, v235, v251
v_lshlrev_b32 v235, 4, v235
v_mul_u32_u24 v236, 384, v250
v_add_u32 v236, 125952, v236
v_xor_b32 v144, 64, v235
v_add_u32 v235, v235, v236
v_add_u32 v236, v144, v236
v_and_b32 v144, 1, v251
v_mul_u32_u24 v144, 6144, v144
v_mul_u32_u24 v145, 384, v250
v_add_u32 v144, v144, v145
v_add_u32 v144, 101376, v144
v_lshrrev_b32 v145, 1, v251
s_mul_i32 s30, s24, 6
v_add_u32 v145, s30, v145
v_and_b32 v146, 7, v250
v_add_u32 v147, 0, v145
v_xor_b32 v147, v147, v146
v_lshl_add_u32 v237, v147, 4, v144
v_add_u32 v147, 2, v145
v_xor_b32 v147, v147, v146
v_lshl_add_u32 v238, v147, 4, v144
v_add_u32 v147, 4, v145
v_xor_b32 v147, v147, v146
v_lshl_add_u32 v239, v147, 4, v144
s_lshl_b32 s28, s24, 2
v_add_u32 v144, s28, v251
v_and_b32 v145, 7, v144
v_xor_b32 v145, v145, v249
v_mul_u32_u24 v144, 384, v144
v_lshl_add_u32 v240, v145, 4, v144
v_add_u32 v240, 101376, v240
v_and_b32 v144, 1, v251
v_lshlrev_b32 v144, 2, v144
v_lshrrev_b32 v145, 5, v252
v_or_b32 v144, v144, v145
v_xor_b32 v144, v144, v249
v_lshlrev_b32 v144, 4, v144
s_mul_i32 s28, s24, 6144
v_mul_u32_u24 v145, 384, v248
v_add_u32 v145, s28, v145
v_add_u32 v241, v144, v145
v_xor_b32 v144, 32, v144
v_add_u32 v242, v144, v145
v_add_u32 v242, 3072, v242
v_lshrrev_b32 v144, 1, v250
v_xor_b32 v144, v144, v251
v_lshlrev_b32 v144, 4, v144
v_mul_u32_u24 v145, 384, v250
v_add_u32 v145, s28, v145
v_add_u32 v243, v144, v145
v_xor_b32 v144, 64, v144
v_add_u32 v244, v144, v145
v_bfe_u32 v144, v252, 2, 1
v_lshl_add_u32 v144, v144, 3, v248
s_lshl_b32 s28, s24, 6
s_add_u32 s28, s28, 24576
v_lshl_add_u32 v245, v144, 2, s28
v_bfe_u32 v144, v252, 2, 2
v_lshl_add_u32 v144, v251, 3, v144
v_mul_u32_u24 v144, 384, v144
v_and_b32 v145, 1, v252
v_lshl_add_u32 v144, v145, 3, v144
v_bfe_u32 v145, v252, 3, 2
v_lshlrev_b32 v145, 1, v145
v_bfe_u32 v146, v252, 1, 1
v_add_u32 v146, s30, v146
v_add_u32 v147, 0, v146
v_xor_b32 v147, v147, v145
v_lshl_add_u32 v216, v147, 4, v144
v_add_u32 v147, 2, v146
v_xor_b32 v147, v147, v145
v_lshl_add_u32 v217, v147, 4, v144
v_add_u32 v147, 4, v146
v_xor_b32 v147, v147, v145
v_lshl_add_u32 v218, v147, 4, v144
v_lshlrev_b32 v144, 2, v251
v_sub_u32 v144, v250, v144
v_mov_b32 v145, 0x3f80
v_mov_b32 v146, 1.0
v_cmp_eq_u32 vcc, 0, v144
s_nop 1
v_cndmask_b32 v232, 0, v145, vcc
v_cmp_eq_u32 vcc, 1, v144
s_nop 1
v_cndmask_b32 v232, v232, v146, vcc
v_cmp_eq_u32 vcc, 2, v144
s_nop 1
v_cndmask_b32 v233, 0, v145, vcc
v_cmp_eq_u32 vcc, 3, v144
s_nop 1
v_cndmask_b32 v233, v233, v146, vcc
v_mov_b32 v228, 0x3f803f80
v_mov_b32 v229, 0x3f803f80
v_mov_b32 v230, 0x3f803f80
v_mov_b32 v231, 0x3f803f80
s_mov_b32 s36, 12288
s_mov_b32 s38, 0
s_movk_i32 s46, 6144
s_mov_b32 s47, 25344
s_mov_b32 s27, 0
s_mov_b32 s31, 4
s_mov_b32 s0, 0x11111111
s_mov_b32 s1, s0
s_waitcnt lgkmcnt(0)
s_mul_i32 s7, s7, 1664525
s_add_u32 s7, s7, 1013904223
s_or_b32 s7, s7, 1
s_barrier
PP_is2:
s_add_u32 m0, s33, 12288
s_mov_b64 exec, s[42:43]
buffer_load_dwordx4 v246, s[12:15], s29 offen nt lds
buffer_load_dwordx4 v247, s[12:15], s29 offen offset:768 nt lds
s_mov_b64 exec, -1
s_add_u32 s29, s29, 6144
s_add_u32 s41, s26, 196608
buffer_load_dwordx4 v[72:75], v234, s[8:11], s26 offen offset:0 nt
buffer_load_dwordx4 v[76:79], v234, s[8:11], s26 offen offset:128 nt
buffer_load_dwordx4 v[80:83], v234, s[8:11], s26 offen offset:256 nt
buffer_load_dwordx4 v[84:87], v234, s[8:11], s41 offen offset:0 nt
buffer_load_dwordx4 v[88:91], v234, s[8:11], s41 offen offset:128 nt
buffer_load_dwordx4 v[92:95], v234, s[8:11], s41 offen offset:256 nt
s_add_u32 s26, s26, 12288
s_add_u32 m0, s33, 18432
s_mov_b64 exec, s[42:43]
buffer_load_dwordx4 v246, s[12:15], s29 offen nt lds
buffer_load_dwordx4 v247, s[12:15], s29 offen offset:768 nt lds
s_mov_b64 exec, -1
s_add_u32 s29, s29, 6144
PP_is3:
s_mov_b32 s34, 0x3baaaaab
s_mov_b32 s35, 0x3727c5ac
s_mov_b32 s16, s2
s_cmp_lt_i32 s5, 0
s_cselect_b32 s16, s16, 0
s_cmp_lt_u32 s2, 152
s_cselect_b32 s16, 0, s16
s_mov_b32 s17, 0x66666666
s_cmp_lt_u32 s16, 128
s_cselect_b32 s17, 0x33333333, s17
s_and_b32 s18, s2, 7
s_lshl_b32 s18, s18, 2
s_lshr_b32 s17, s17, s18
s_and_b32 s17, s17, 15
s_add_u32 s18, s17, 1
s_waitcnt vmcnt(10)
s_lshl_b32 s6, s24, 2
s_add_u32 s6, s6, 158752
v_mov_b32 v144, s6
v_mov_b32 v145, 1
ds_write_b32 v144, v145
v_lshlrev_b32 v144, 2, v252
v_and_b32 v144, 31, v144
v_add_u32 v144, 158752, v144
FW1:
ds_read_b32 v145, v144
s_waitcnt lgkmcnt(0)
v_cmp_eq_u32 vcc, 1, v145
s_and_b32 s6, vcc_lo, 255
s_cmp_eq_u32 s6, 255
s_cbranch_scc0 FW1
ds_read_b128 v[192:195], v235 offset:0
ds_read_b128 v[196:199], v236 offset:0
ds_read_b128 v[200:203], v235 offset:128
ds_read_b128 v[204:207], v236 offset:128
ds_read_b128 v[208:211], v235 offset:256
ds_read_b128 v[212:215], v236 offset:256
s_add_u32 s38, s38, 1
s_and_b32 s38, s38, 3
s_cmp_eq_u32 s38, 0
s_cselect_b32 s30, 0xffffb800, s46
v_add_u32 v235, s30, v235
v_add_u32 v236, s30, v236
ds_read_b64_tr_b16 v[0:1], v216 offset:0
ds_read_b64_tr_b16 v[2:3], v216 offset:1536
ds_read_b64_tr_b16 v[24:25], v217 offset:0
ds_read_b64_tr_b16 v[26:27], v217 offset:1536
ds_read_b64_tr_b16 v[48:49], v218 offset:0
ds_read_b64_tr_b16 v[50:51], v218 offset:1536
ds_read_b64_tr_b16 v[4:5], v216 offset:12288
ds_read_b64_tr_b16 v[6:7], v216 offset:13824
ds_read_b64_tr_b16 v[28:29], v217 offset:12288
ds_read_b64_tr_b16 v[30:31], v217 offset:13824
ds_read_b64_tr_b16 v[52:53], v218 offset:12288
ds_read_b64_tr_b16 v[54:55], v218 offset:13824
ds_read_b64_tr_b16 v[8:9], v216 offset:24576
ds_read_b64_tr_b16 v[10:11], v216 offset:26112
ds_read_b64_tr_b16 v[32:33], v217 offset:24576
ds_read_b64_tr_b16 v[34:35], v217 offset:26112
ds_read_b64_tr_b16 v[56:57], v218 offset:24576
ds_read_b64_tr_b16 v[58:59], v218 offset:26112
ds_read_b64_tr_b16 v[12:13], v216 offset:36864
ds_read_b64_tr_b16 v[14:15], v216 offset:38400
ds_read_b64_tr_b16 v[36:37], v217 offset:36864
ds_read_b64_tr_b16 v[38:39], v217 offset:38400
ds_read_b64_tr_b16 v[60:61], v218 offset:36864
ds_read_b64_tr_b16 v[62:63], v218 offset:38400
ds_read_b64_tr_b16 v[16:17], v216 offset:49152
ds_read_b64_tr_b16 v[18:19], v216 offset:50688
ds_read_b64_tr_b16 v[40:41], v217 offset:49152
ds_read_b64_tr_b16 v[42:43], v217 offset:50688
ds_read_b64_tr_b16 v[64:65], v218 offset:49152
ds_read_b64_tr_b16 v[66:67], v218 offset:50688
ds_read_b64_tr_b16 v[20:21], v216 offset:61440
ds_read_b64_tr_b16 v[22:23], v216 offset:62976
ds_read_b64_tr_b16 v[44:45], v217 offset:61440
ds_read_b64_tr_b16 v[46:47], v217 offset:62976
ds_read_b64_tr_b16 v[68:69], v218 offset:61440
ds_read_b64_tr_b16 v[70:71], v218 offset:62976
ds_read_b128 v[168:171], v235 offset:0
ds_read_b128 v[172:175], v236 offset:0
ds_read_b128 v[176:179], v235 offset:128
ds_read_b128 v[180:183], v236 offset:128
ds_read_b128 v[184:187], v235 offset:256
ds_read_b128 v[188:191], v236 offset:256
s_add_u32 s38, s38, 1
s_and_b32 s38, s38, 3
s_cmp_eq_u32 s38, 0
s_cselect_b32 s30, 0xffffb800, s46
v_add_u32 v235, s30, v235
v_add_u32 v236, s30, v236
s_add_u32 s41, s26, 196608
buffer_load_dwordx4 v[96:99], v234, s[8:11], s26 offen offset:0 nt
buffer_load_dwordx4 v[100:103], v234, s[8:11], s26 offen offset:128 nt
buffer_load_dwordx4 v[104:107], v234, s[8:11], s26 offen offset:256 nt
buffer_load_dwordx4 v[108:111], v234, s[8:11], s41 offen offset:0 nt
buffer_load_dwordx4 v[112:115], v234, s[8:11], s41 offen offset:128 nt
buffer_load_dwordx4 v[116:119], v234, s[8:11], s41 offen offset:256 nt
s_add_u32 s26, s26, 12288
s_waitcnt lgkmcnt(15)
v_mfma_f32_16x16x32_bf16 v[144:147], v[0:3], v[192:195], 0
v_mfma_f32_16x16x32_bf16 v[148:151], v[24:27], v[192:195], 0
v_mfma_f32_16x16x32_bf16 v[152:155], v[48:51], v[192:195], 0
s_waitcnt lgkmcnt(15)
v_mfma_f32_16x16x32_bf16 v[144:147], v[4:7], v[196:199], v[144:147]
v_mfma_f32_16x16x32_bf16 v[148:151], v[28:31], v[196:199], v[148:151]
v_mfma_f32_16x16x32_bf16 v[152:155], v[52:55], v[196:199], v[152:155]
s_waitcnt lgkmcnt(15)
v_mfma_f32_16x16x32_bf16 v[144:147], v[8:11], v[200:203], v[144:147]
v_mfma_f32_16x16x32_bf16 v[148:151], v[32:35], v[200:203], v[148:151]
v_mfma_f32_16x16x32_bf16 v[152:155], v[56:59], v[200:203], v[152:155]
s_waitcnt lgkmcnt(15)
v_mfma_f32_16x16x32_bf16 v[144:147], v[12:15], v[204:207], v[144:147]
v_mfma_f32_16x16x32_bf16 v[148:151], v[36:39], v[204:207], v[148:151]
v_mfma_f32_16x16x32_bf16 v[152:155], v[60:63], v[204:207], v[152:155]
s_waitcnt lgkmcnt(12)
v_mfma_f32_16x16x32_bf16 v[144:147], v[16:19], v[208:211], v[144:147]
v_mfma_f32_16x16x32_bf16 v[148:151], v[40:43], v[208:211], v[148:151]
v_mfma_f32_16x16x32_bf16 v[152:155], v[64:67], v[208:211], v[152:155]
s_waitcnt lgkmcnt(6)
v_mfma_f32_16x16x32_bf16 v[144:147], v[20:23], v[212:215], v[144:147]
v_mfma_f32_16x16x32_bf16 v[148:151], v[44:47], v[212:215], v[148:151]
v_mfma_f32_16x16x32_bf16 v[152:155], v[68:71], v[212:215], v[152:155]
s_waitcnt lgkmcnt(0)
v_mfma_f32_16x16x32_bf16 v[216:219], v[0:3], v[168:171], 0
v_mfma_f32_16x16x32_bf16 v[220:223], v[24:27], v[168:171], 0
v_mfma_f32_16x16x32_bf16 v[224:227], v[48:51], v[168:171], 0
v_mfma_f32_16x16x32_bf16 v[216:219], v[4:7], v[172:175], v[216:219]
v_mfma_f32_16x16x32_bf16 v[220:223], v[28:31], v[172:175], v[220:223]
v_mfma_f32_16x16x32_bf16 v[224:227], v[52:55], v[172:175], v[224:227]
v_mfma_f32_16x16x32_bf16 v[216:219], v[8:11], v[176:179], v[216:219]
v_mfma_f32_16x16x32_bf16 v[220:223], v[32:35], v[176:179], v[220:223]
v_mfma_f32_16x16x32_bf16 v[224:227], v[56:59], v[176:179], v[224:227]
ds_write_b128 v237, v[144:147] offset:0
ds_write_b128 v238, v[148:151] offset:0
ds_write_b128 v239, v[152:155] offset:0
v_mfma_f32_16x16x32_bf16 v[216:219], v[12:15], v[180:183], v[216:219]
v_mfma_f32_16x16x32_bf16 v[220:223], v[36:39], v[180:183], v[220:223]
v_mfma_f32_16x16x32_bf16 v[224:227], v[60:63], v[180:183], v[224:227]
v_mfma_f32_16x16x32_bf16 v[216:219], v[16:19], v[184:187], v[216:219]
v_mfma_f32_16x16x32_bf16 v[220:223], v[40:43], v[184:187], v[220:223]
v_mfma_f32_16x16x32_bf16 v[224:227], v[64:67], v[184:187], v[224:227]
s_waitcnt vmcnt(14) lgkmcnt(0)
s_lshl_b32 s6, s24, 2
s_add_u32 s6, s6, 158784
v_mov_b32 v248, s6
v_mov_b32 v249, 1
ds_write_b32 v248, v249
v_mfma_f32_16x16x32_bf16 v[216:219], v[20:23], v[188:191], v[216:219]
v_mfma_f32_16x16x32_bf16 v[220:223], v[44:47], v[188:191], v[220:223]
v_mfma_f32_16x16x32_bf16 v[224:227], v[68:71], v[188:191], v[224:227]
s_nop 7
ds_write_b128 v237, v[216:219] offset:12288
ds_write_b128 v238, v[220:223] offset:12288
ds_write_b128 v239, v[224:227] offset:12288
v_lshlrev_b32 v248, 2, v252
v_and_b32 v248, 31, v248
v_add_u32 v248, 158784, v248
FW2:
ds_read_b32 v249, v248
s_waitcnt lgkmcnt(0)
v_cmp_eq_u32 vcc, 1, v249
s_and_b32 s6, vcc_lo, 15
s_cmp_eq_u32 s6, 15
s_cbranch_scc0 FW2
ds_read_b128 v[144:147], v240 offset:0
ds_read_b128 v[148:151], v240 offset:6144
ds_read_b128 v[152:155], v240 offset:128
ds_read_b128 v[156:159], v240 offset:6272
ds_read_b128 v[160:163], v240 offset:256
ds_read_b128 v[164:167], v240 offset:6400
ds_read_b128 v[192:195], v235 offset:0
ds_read_b128 v[196:199], v236 offset:0
ds_read_b128 v[200:203], v235 offset:128
ds_read_b128 v[204:207], v236 offset:128
ds_read_b128 v[208:211], v235 offset:256
ds_read_b128 v[212:215], v236 offset:256
s_add_u32 s38, s38, 1
s_and_b32 s38, s38, 3
s_cmp_eq_u32 s38, 0
s_cselect_b32 s30, 0xffffb800, s46
v_add_u32 v235, s30, v235
v_add_u32 v236, s30, v236
v_add_u32 v240, s36, v240
s_waitcnt vmcnt(6) lgkmcnt(0)
s_barrier
s_and_b32 s32, s31, 3
s_mul_i32 s32, s32, 6144
s_add_u32 m0, s32, s33
s_add_u32 s31, s31, 1
s_cmp_le_u32 s31, 16
s_cselect_b32 s14, s14, 0
s_mov_b64 exec, s[42:43]
buffer_load_dwordx4 v246, s[12:15], s29 offen nt lds
buffer_load_dwordx4 v247, s[12:15], s29 offen offset:768 nt lds
s_mov_b64 exec, -1
s_add_u32 s29, s29, 6144
s_waitcnt lgkmcnt(6)
v_mfma_f32_16x16x16_bf16 v[168:171], v[232:233], v[84:85], v[144:147]
v_mfma_f32_16x16x16_bf16 v[172:175], v[232:233], v[86:87], v[148:151]
v_mfma_f32_16x16x16_bf16 v[176:179], v[232:233], v[88:89], v[152:155]
v_mfma_f32_16x16x16_bf16 v[180:183], v[232:233], v[90:91], v[156:159]
v_mfma_f32_16x16x16_bf16 v[184:187], v[232:233], v[92:93], v[160:163]
v_mfma_f32_16x16x16_bf16 v[188:191], v[232:233], v[94:95], v[164:167]
s_mov_b32 s40, s26
s_add_u32 s41, s26, 196608
s_add_u32 s26, s26, 12288
v_mfma_f32_16x16x16_bf16 v[144:147], v[232:233], v[72:73], v[144:147]
v_cvt_pk_bf16_f32 v168, v168, v169
v_cvt_pk_bf16_f32 v169, v170, v171
v_cvt_pk_bf16_f32 v170, v172, v173
v_cvt_pk_bf16_f32 v171, v174, v175
v_mfma_f32_16x16x16_bf16 v[148:151], v[232:233], v[74:75], v[148:151]
v_cvt_pk_bf16_f32 v176, v176, v177
v_cvt_pk_bf16_f32 v177, v178, v179
v_cvt_pk_bf16_f32 v178, v180, v181
v_cvt_pk_bf16_f32 v179, v182, v183
v_mfma_f32_16x16x16_bf16 v[152:155], v[232:233], v[76:77], v[152:155]
v_cvt_pk_bf16_f32 v184, v184, v185
v_cvt_pk_bf16_f32 v185, v186, v187
v_cvt_pk_bf16_f32 v186, v188, v189
v_cvt_pk_bf16_f32 v187, v190, v191
v_mfma_f32_16x16x16_bf16 v[156:159], v[232:233], v[78:79], v[156:159]
v_mfma_f32_16x16x16_bf16 v[160:163], v[232:233], v[80:81], v[160:163]
v_mfma_f32_16x16x16_bf16 v[164:167], v[232:233], v[82:83], v[164:167]
s_setprio 0
ds_write_b128 v242, v[168:171] offset:0
v_cvt_pk_bf16_f32 v144, v144, v145
v_cvt_pk_bf16_f32 v145, v146, v147
v_cvt_pk_bf16_f32 v146, v148, v149
v_cvt_pk_bf16_f32 v147, v150, v151
ds_write_b128 v242, v[176:179] offset:128
v_cvt_pk_bf16_f32 v152, v152, v153
v_cvt_pk_bf16_f32 v153, v154, v155
v_cvt_pk_bf16_f32 v154, v156, v157
v_cvt_pk_bf16_f32 v155, v158, v159
ds_write_b128 v242, v[184:187] offset:256
v_cvt_pk_bf16_f32 v160, v160, v161
v_cvt_pk_bf16_f32 v161, v162, v163
v_cvt_pk_bf16_f32 v162, v164, v165
v_cvt_pk_bf16_f32 v163, v166, v167
ds_write_b128 v241, v[144:147] offset:0
ds_write_b128 v241, v[152:155] offset:128
ds_write_b128 v241, v[160:163] offset:256
s_setprio 0
s_add_u32 s27, s27, 1
s_and_b32 s28, s27, 3
s_cmp_eq_u32 s28, 0
s_cselect_b32 s28, 0xfffed700, s47
v_add_u32 v241, s28, v241
v_add_u32 v242, s28, v242
v_dot2_f32_bf16 v249, v168, v168, 0
v_dot2_f32_bf16 v251, v168, v228, 0
v_dot2_f32_bf16 v249, v169, v169, v249
v_dot2_f32_bf16 v251, v169, v228, v251
v_dot2_f32_bf16 v249, v170, v170, v249
v_dot2_f32_bf16 v251, v170, v228, v251
v_dot2_f32_bf16 v249, v171, v171, v249
v_dot2_f32_bf16 v251, v171, v228, v251
v_dot2_f32_bf16 v249, v176, v176, v249
v_dot2_f32_bf16 v251, v176, v228, v251
v_dot2_f32_bf16 v249, v177, v177, v249
v_dot2_f32_bf16 v251, v177, v228, v251
v_dot2_f32_bf16 v249, v178, v178, v249
v_dot2_f32_bf16 v251, v178, v228, v251
v_dot2_f32_bf16 v249, v179, v179, v249
v_dot2_f32_bf16 v251, v179, v228, v251
v_dot2_f32_bf16 v249, v184, v184, v249
v_dot2_f32_bf16 v251, v184, v228, v251
v_dot2_f32_bf16 v249, v185, v185, v249
v_dot2_f32_bf16 v251, v185, v228, v251
v_dot2_f32_bf16 v249, v186, v186, v249
v_dot2_f32_bf16 v251, v186, v228, v251
v_dot2_f32_bf16 v249, v187, v187, v249
v_dot2_f32_bf16 v251, v187, v228, v251
v_dot2_f32_bf16 v248, v144, v144, 0
v_dot2_f32_bf16 v250, v144, v228, 0
v_dot2_f32_bf16 v248, v145, v145, v248
v_dot2_f32_bf16 v250, v145, v228, v250
v_dot2_f32_bf16 v248, v146, v146, v248
v_dot2_f32_bf16 v250, v146, v228, v250
v_dot2_f32_bf16 v248, v147, v147, v248
v_dot2_f32_bf16 v250, v147, v228, v250
v_dot2_f32_bf16 v248, v152, v152, v248
v_dot2_f32_bf16 v250, v152, v228, v250
v_dot2_f32_bf16 v248, v153, v153, v248
v_dot2_f32_bf16 v250, v153, v228, v250
v_dot2_f32_bf16 v248, v154, v154, v248
v_dot2_f32_bf16 v250, v154, v228, v250
v_dot2_f32_bf16 v248, v155, v155, v248
v_dot2_f32_bf16 v250, v155, v228, v250
v_dot2_f32_bf16 v248, v160, v160, v248
v_dot2_f32_bf16 v250, v160, v228, v250
v_dot2_f32_bf16 v248, v161, v161, v248
v_dot2_f32_bf16 v250, v161, v228, v250
v_dot2_f32_bf16 v248, v162, v162, v248
v_dot2_f32_bf16 v250, v162, v228, v250
v_dot2_f32_bf16 v248, v163, v163, v248
v_dot2_f32_bf16 v250, v163, v228, v250
s_setprio 3
s_waitcnt lgkmcnt(6)
v_mfma_f32_16x16x32_bf16 v[216:219], v[0:3], v[192:195], 0
v_mfma_f32_16x16x32_bf16 v[220:223], v[24:27], v[192:195], 0
v_mfma_f32_16x16x32_bf16 v[224:227], v[48:51], v[192:195], 0
v_mfma_f32_16x16x32_bf16 v[216:219], v[4:7], v[196:199], v[216:219]
v_mfma_f32_16x16x32_bf16 v[220:223], v[28:31], v[196:199], v[220:223]
v_mfma_f32_16x16x32_bf16 v[224:227], v[52:55], v[196:199], v[224:227]
v_mfma_f32_16x16x32_bf16 v[216:219], v[8:11], v[200:203], v[216:219]
v_mfma_f32_16x16x32_bf16 v[220:223], v[32:35], v[200:203], v[220:223]
v_mfma_f32_16x16x32_bf16 v[224:227], v[56:59], v[200:203], v[224:227]
v_mfma_f32_16x16x32_bf16 v[216:219], v[12:15], v[204:207], v[216:219]
v_mfma_f32_16x16x32_bf16 v[220:223], v[36:39], v[204:207], v[220:223]
v_add_f32_dpp v249, v249, v249 row_half_mirror row_mask:0xf bank_mask:0xa
v_add_f32_dpp v251, v251, v251 row_half_mirror row_mask:0xf bank_mask:0xa
v_mfma_f32_16x16x32_bf16 v[224:227], v[60:63], v[204:207], v[224:227]
v_add_f32_dpp v249, v248, v248 row_half_mirror row_mask:0xf bank_mask:0x5
v_add_f32_dpp v251, v250, v250 row_half_mirror row_mask:0xf bank_mask:0x5
v_mfma_f32_16x16x32_bf16 v[216:219], v[16:19], v[208:211], v[216:219]
v_add_f32_dpp v249, v249, v249 quad_perm:[1,0,3,2] row_mask:0xf bank_mask:0xf
v_add_f32_dpp v251, v251, v251 quad_perm:[1,0,3,2] row_mask:0xf bank_mask:0xf
v_mfma_f32_16x16x32_bf16 v[220:223], v[40:43], v[208:211], v[220:223]
v_add_f32_dpp v249, v249, v249 quad_perm:[2,3,0,1] row_mask:0xf bank_mask:0xf
v_add_f32_dpp v251, v251, v251 quad_perm:[2,3,0,1] row_mask:0xf bank_mask:0xf
v_mfma_f32_16x16x32_bf16 v[224:227], v[64:67], v[208:211], v[224:227]
v_mul_f32 v172, s34, v251
v_fma_f32 v173, -v172, v172, s35
v_mfma_f32_16x16x32_bf16 v[216:219], v[20:23], v[212:215], v[216:219]
v_cvt_pk_bf16_f32 v174, v172, v172
v_fma_f32 v248, v249, s34, v173
v_mfma_f32_16x16x32_bf16 v[220:223], v[44:47], v[212:215], v[220:223]
v_and_b32 v175, 0xffff0000, v174
v_max_f32 v248, s35, v248
v_mfma_f32_16x16x32_bf16 v[224:227], v[68:71], v[212:215], v[224:227]
v_sub_f32 v172, v172, v175
v_rsq_f32 v248, v248
v_cvt_pk_bf16_f32 v175, v175, v172
s_mov_b64 exec, s[0:1]
ds_write2st64_b32 v245, v175, v174 offset0:1 offset1:2
ds_write_b32 v245, v248
s_mov_b64 exec, -1
v_add_u32 v245, s28, v245
ds_write_b128 v237, v[216:219] offset:0
ds_write_b128 v238, v[220:223] offset:0
ds_write_b128 v239, v[224:227] offset:0
v_add_u32 v237, s36, v237
v_add_u32 v238, s36, v238
v_add_u32 v239, s36, v239
s_setprio 0
ds_read_b128 v[144:147], v240 offset:0
ds_read_b128 v[148:151], v240 offset:6144
ds_read_b128 v[152:155], v240 offset:128
ds_read_b128 v[156:159], v240 offset:6272
ds_read_b128 v[160:163], v240 offset:256
ds_read_b128 v[164:167], v240 offset:6400
v_subrev_u32 v240, s36, v240
ds_read_b128 v[192:195], v235 offset:0
ds_read_b128 v[196:199], v236 offset:0
ds_read_b128 v[200:203], v235 offset:128
ds_read_b128 v[204:207], v236 offset:128
ds_read_b128 v[208:211], v235 offset:256
ds_read_b128 v[212:215], v236 offset:256
s_add_u32 s38, s38, 1
s_and_b32 s38, s38, 3
s_cmp_eq_u32 s38, 0
s_cselect_b32 s30, 0xffffb800, s46
v_add_u32 v235, s30, v235
v_add_u32 v236, s30, v236
s_sub_u32 s36, 0, s36
buffer_load_dwordx4 v[120:123], v234, s[8:11], s40 offen offset:0 nt
buffer_load_dwordx4 v[124:127], v234, s[8:11], s40 offen offset:128 nt
buffer_load_dwordx4 v[128:131], v234, s[8:11], s40 offen offset:256 nt
buffer_load_dwordx4 v[132:135], v234, s[8:11], s41 offen offset:0 nt
buffer_load_dwordx4 v[136:139], v234, s[8:11], s41 offen offset:128 nt
buffer_load_dwordx4 v[140:143], v234, s[8:11], s41 offen offset:256 nt
s_and_b32 s32, s31, 3
s_mul_i32 s32, s32, 6144
s_add_u32 m0, s32, s33
s_add_u32 s31, s31, 1
s_cmp_le_u32 s31, 16
s_cselect_b32 s14, s14, 0
s_mov_b64 exec, s[42:43]
buffer_load_dwordx4 v246, s[12:15], s29 offen nt lds
buffer_load_dwordx4 v247, s[12:15], s29 offen offset:768 nt lds
s_mov_b64 exec, -1
s_add_u32 s29, s29, 6144
s_waitcnt lgkmcnt(12)
s_setprio 3
s_barrier
s_add_u32 s41, s26, 196608
buffer_load_dwordx4 v[72:75], v234, s[8:11], s26 offen offset:0 nt
buffer_load_dwordx4 v[76:79], v234, s[8:11], s26 offen offset:128 nt
buffer_load_dwordx4 v[80:83], v234, s[8:11], s26 offen offset:256 nt
buffer_load_dwordx4 v[84:87], v234, s[8:11], s41 offen offset:0 nt
buffer_load_dwordx4 v[88:91], v234, s[8:11], s41 offen offset:128 nt
buffer_load_dwordx4 v[92:95], v234, s[8:11], s41 offen offset:256 nt
s_add_u32 s26, s26, 12288
s_and_b32 s32, s31, 3
s_mul_i32 s32, s32, 6144
s_add_u32 m0, s32, s33
s_add_u32 s31, s31, 1
s_cmp_le_u32 s31, 16
s_cselect_b32 s14, s14, 0
s_mov_b64 exec, s[42:43]
buffer_load_dwordx4 v246, s[12:15], s29 offen nt lds
buffer_load_dwordx4 v247, s[12:15], s29 offen offset:768 nt lds
s_mov_b64 exec, -1
s_add_u32 s29, s29, 6144
s_waitcnt vmcnt(16)
s_lshl_b32 s6, s24, 2
s_add_u32 s6, s6, 158720
v_mov_b32 v248, s6
v_mov_b32 v249, 1
ds_write_b32 v248, v249
s_waitcnt lgkmcnt(1)
s_branch PL_body2
PL_loop:
s_barrier
s_waitcnt lgkmcnt(6)
PL_body2:
v_mfma_f32_16x16x16_bf16 v[168:171], v[232:233], v[108:109], v[144:147]
v_mfma_f32_16x16x16_bf16 v[172:175], v[232:233], v[110:111], v[148:151]
v_mfma_f32_16x16x16_bf16 v[176:179], v[232:233], v[112:113], v[152:155]
v_mfma_f32_16x16x16_bf16 v[180:183], v[232:233], v[114:115], v[156:159]
v_mfma_f32_16x16x16_bf16 v[184:187], v[232:233], v[116:117], v[160:163]
v_mfma_f32_16x16x16_bf16 v[188:191], v[232:233], v[118:119], v[164:167]
s_mov_b32 s40, s26
s_add_u32 s41, s26, 196608
s_add_u32 s26, s26, 12288
v_mfma_f32_16x16x16_bf16 v[144:147], v[232:233], v[96:97], v[144:147]
v_cvt_pk_bf16_f32 v168, v168, v169
v_cvt_pk_bf16_f32 v169, v170, v171
v_cvt_pk_bf16_f32 v170, v172, v173
v_cvt_pk_bf16_f32 v171, v174, v175
v_mfma_f32_16x16x16_bf16 v[148:151], v[232:233], v[98:99], v[148:151]
v_cvt_pk_bf16_f32 v176, v176, v177
v_cvt_pk_bf16_f32 v177, v178, v179
v_cvt_pk_bf16_f32 v178, v180, v181
v_cvt_pk_bf16_f32 v179, v182, v183
v_mfma_f32_16x16x16_bf16 v[152:155], v[232:233], v[100:101], v[152:155]
v_cvt_pk_bf16_f32 v184, v184, v185
v_cvt_pk_bf16_f32 v185, v186, v187
v_cvt_pk_bf16_f32 v186, v188, v189
v_cvt_pk_bf16_f32 v187, v190, v191
v_mfma_f32_16x16x16_bf16 v[156:159], v[232:233], v[102:103], v[156:159]
v_mfma_f32_16x16x16_bf16 v[160:163], v[232:233], v[104:105], v[160:163]
v_mfma_f32_16x16x16_bf16 v[164:167], v[232:233], v[106:107], v[164:167]
s_setprio 0
s_cmp_lt_u32 s27, s17
ds_write_b128 v242, v[168:171] offset:0
s_cbranch_scc1 PK3
buffer_load_dwordx4 v[108:111], v234, s[8:11], s41 offen offset:0 nt
PK3:
v_cvt_pk_bf16_f32 v144, v144, v145
v_cvt_pk_bf16_f32 v145, v146, v147
v_cvt_pk_bf16_f32 v146, v148, v149
v_cvt_pk_bf16_f32 v147, v150, v151
ds_write_b128 v242, v[176:179] offset:128
s_cbranch_scc1 PK4
buffer_load_dwordx4 v[112:115], v234, s[8:11], s41 offen offset:128 nt
PK4:
v_cvt_pk_bf16_f32 v152, v152, v153
v_cvt_pk_bf16_f32 v153, v154, v155
v_cvt_pk_bf16_f32 v154, v156, v157
v_cvt_pk_bf16_f32 v155, v158, v159
ds_write_b128 v242, v[184:187] offset:256
s_cbranch_scc1 PK5
buffer_load_dwordx4 v[116:119], v234, s[8:11], s41 offen offset:256 nt
PK5:
v_cvt_pk_bf16_f32 v160, v160, v161
v_cvt_pk_bf16_f32 v161, v162, v163
v_cvt_pk_bf16_f32 v162, v164, v165
v_cvt_pk_bf16_f32 v163, v166, v167
ds_write_b128 v241, v[144:147] offset:0
s_cbranch_scc1 PK6
buffer_load_dwordx4 v[96:99], v234, s[8:11], s40 offen offset:0 nt
PK6:
ds_write_b128 v241, v[152:155] offset:128
s_cbranch_scc1 PK7
buffer_load_dwordx4 v[100:103], v234, s[8:11], s40 offen offset:128 nt
PK7:
ds_write_b128 v241, v[160:163] offset:256
s_cbranch_scc1 PK8
buffer_load_dwordx4 v[104:107], v234, s[8:11], s40 offen offset:256 nt
PK8:
s_setprio 0
s_add_u32 s27, s27, 1
s_and_b32 s28, s27, 3
s_cmp_eq_u32 s28, 0
s_cselect_b32 s28, 0xfffed700, s47
v_add_u32 v241, s28, v241
v_add_u32 v242, s28, v242
s_cmp_lt_u32 s16, 128
s_cbranch_scc1 PA9
s_setprio 3
s_waitcnt lgkmcnt(6)
v_mfma_f32_16x16x32_bf16 v[216:219], v[0:3], v[192:195], 0
v_dot2_f32_bf16 v249, v168, v168, 0
v_dot2_f32_bf16 v251, v168, v228, 0
v_mfma_f32_16x16x32_bf16 v[220:223], v[24:27], v[192:195], 0
v_dot2_f32_bf16 v249, v169, v169, v249
v_dot2_f32_bf16 v251, v169, v228, v251
v_mfma_f32_16x16x32_bf16 v[224:227], v[48:51], v[192:195], 0
v_dot2_f32_bf16 v249, v170, v170, v249
v_dot2_f32_bf16 v251, v170, v228, v251
v_mfma_f32_16x16x32_bf16 v[216:219], v[4:7], v[196:199], v[216:219]
v_dot2_f32_bf16 v249, v171, v171, v249
v_dot2_f32_bf16 v251, v171, v228, v251
v_mfma_f32_16x16x32_bf16 v[220:223], v[28:31], v[196:199], v[220:223]
v_dot2_f32_bf16 v249, v176, v176, v249
v_dot2_f32_bf16 v251, v176, v228, v251
v_mfma_f32_16x16x32_bf16 v[224:227], v[52:55], v[196:199], v[224:227]
v_dot2_f32_bf16 v249, v177, v177, v249
v_dot2_f32_bf16 v251, v177, v228, v251
v_mfma_f32_16x16x32_bf16 v[216:219], v[8:11], v[200:203], v[216:219]
v_dot2_f32_bf16 v249, v178, v178, v249
v_dot2_f32_bf16 v251, v178, v228, v251
v_mfma_f32_16x16x32_bf16 v[220:223], v[32:35], v[200:203], v[220:223]
v_dot2_f32_bf16 v249, v179, v179, v249
v_dot2_f32_bf16 v251, v179, v228, v251
v_mfma_f32_16x16x32_bf16 v[224:227], v[56:59], v[200:203], v[224:227]
v_dot2_f32_bf16 v249, v184, v184, v249
v_dot2_f32_bf16 v251, v184, v228, v251
v_mfma_f32_16x16x32_bf16 v[216:219], v[12:15], v[204:207], v[216:219]
v_dot2_f32_bf16 v249, v185, v185, v249
v_dot2_f32_bf16 v251, v185, v228, v251
v_mfma_f32_16x16x32_bf16 v[220:223], v[36:39], v[204:207], v[220:223]
v_dot2_f32_bf16 v249, v186, v186, v249
v_dot2_f32_bf16 v251, v186, v228, v251
v_mfma_f32_16x16x32_bf16 v[224:227], v[60:63], v[204:207], v[224:227]
v_dot2_f32_bf16 v249, v187, v187, v249
v_dot2_f32_bf16 v251, v187, v228, v251
v_mfma_f32_16x16x32_bf16 v[216:219], v[16:19], v[208:211], v[216:219]
v_dot2_f32_bf16 v248, v144, v144, 0
v_dot2_f32_bf16 v250, v144, v228, 0
v_mfma_f32_16x16x32_bf16 v[220:223], v[40:43], v[208:211], v[220:223]
v_dot2_f32_bf16 v248, v145, v145, v248
v_dot2_f32_bf16 v250, v145, v228, v250
v_mfma_f32_16x16x32_bf16 v[224:227], v[64:67], v[208:211], v[224:227]
v_dot2_f32_bf16 v248, v146, v146, v248
v_dot2_f32_bf16 v250, v146, v228, v250
v_mfma_f32_16x16x32_bf16 v[216:219], v[20:23], v[212:215], v[216:219]
v_dot2_f32_bf16 v248, v147, v147, v248
v_dot2_f32_bf16 v250, v147, v228, v250
v_dot2_f32_bf16 v248, v152, v152, v248
v_dot2_f32_bf16 v250, v152, v228, v250
v_dot2_f32_bf16 v248, v153, v153, v248
v_dot2_f32_bf16 v250, v153, v228, v250
v_dot2_f32_bf16 v248, v154, v154, v248
v_dot2_f32_bf16 v250, v154, v228, v250
v_dot2_f32_bf16 v248, v155, v155, v248
v_dot2_f32_bf16 v250, v155, v228, v250
v_dot2_f32_bf16 v248, v160, v160, v248
v_dot2_f32_bf16 v250, v160, v228, v250
v_dot2_f32_bf16 v248, v161, v161, v248
v_dot2_f32_bf16 v250, v161, v228, v250
v_dot2_f32_bf16 v248, v162, v162, v248
v_dot2_f32_bf16 v250, v162, v228, v250
v_dot2_f32_bf16 v248, v163, v163, v248
v_dot2_f32_bf16 v250, v163, v228, v250
v_add_f32_dpp v249, v249, v249 row_half_mirror row_mask:0xf bank_mask:0xa
v_add_f32_dpp v251, v251, v251 row_half_mirror row_mask:0xf bank_mask:0xa
v_mfma_f32_16x16x32_bf16 v[220:223], v[44:47], v[212:215], v[220:223]
v_add_f32_dpp v249, v248, v248 row_half_mirror row_mask:0xf bank_mask:0x5
v_add_f32_dpp v251, v250, v250 row_half_mirror row_mask:0xf bank_mask:0x5
s_nop 0
v_add_f32_dpp v249, v249, v249 quad_perm:[1,0,3,2] row_mask:0xf bank_mask:0xf
v_add_f32_dpp v251, v251, v251 quad_perm:[1,0,3,2] row_mask:0xf bank_mask:0xf
v_mfma_f32_16x16x32_bf16 v[224:227], v[68:71], v[212:215], v[224:227]
v_add_f32_dpp v249, v249, v249 quad_perm:[2,3,0,1] row_mask:0xf bank_mask:0xf
v_add_f32_dpp v251, v251, v251 quad_perm:[2,3,0,1] row_mask:0xf bank_mask:0xf
v_mul_f32 v172, s34, v251
v_fma_f32 v173, -v172, v172, s35
v_cvt_pk_bf16_f32 v174, v172, v172
v_fma_f32 v248, v249, s34, v173
v_and_b32 v175, 0xffff0000, v174
v_max_f32 v248, s35, v248
v_sub_f32 v172, v172, v175
v_rsq_f32 v248, v248
v_cvt_pk_bf16_f32 v175, v175, v172
s_branch PJ9
PA9:
v_dot2_f32_bf16 v249, v168, v168, 0
v_dot2_f32_bf16 v251, v168, v228, 0
v_dot2_f32_bf16 v249, v169, v169, v249
v_dot2_f32_bf16 v251, v169, v228, v251
v_dot2_f32_bf16 v249, v170, v170, v249
v_dot2_f32_bf16 v251, v170, v228, v251
v_dot2_f32_bf16 v249, v171, v171, v249
v_dot2_f32_bf16 v251, v171, v228, v251
v_dot2_f32_bf16 v249, v176, v176, v249
v_dot2_f32_bf16 v251, v176, v228, v251
v_dot2_f32_bf16 v249, v177, v177, v249
v_dot2_f32_bf16 v251, v177, v228, v251
v_dot2_f32_bf16 v249, v178, v178, v249
v_dot2_f32_bf16 v251, v178, v228, v251
v_dot2_f32_bf16 v249, v179, v179, v249
v_dot2_f32_bf16 v251, v179, v228, v251
v_dot2_f32_bf16 v249, v184, v184, v249
v_dot2_f32_bf16 v251, v184, v228, v251
v_dot2_f32_bf16 v249, v185, v185, v249
v_dot2_f32_bf16 v251, v185, v228, v251
v_dot2_f32_bf16 v249, v186, v186, v249
v_dot2_f32_bf16 v251, v186, v228, v251
v_dot2_f32_bf16 v249, v187, v187, v249
v_dot2_f32_bf16 v251, v187, v228, v251
v_dot2_f32_bf16 v248, v144, v144, 0
v_dot2_f32_bf16 v250, v144, v228, 0
v_dot2_f32_bf16 v248, v145, v145, v248
v_dot2_f32_bf16 v250, v145, v228, v250
v_dot2_f32_bf16 v248, v146, v146, v248
v_dot2_f32_bf16 v250, v146, v228, v250
v_dot2_f32_bf16 v248, v147, v147, v248
v_dot2_f32_bf16 v250, v147, v228, v250
v_dot2_f32_bf16 v248, v152, v152, v248
v_dot2_f32_bf16 v250, v152, v228, v250
v_dot2_f32_bf16 v248, v153, v153, v248
v_dot2_f32_bf16 v250, v153, v228, v250
v_dot2_f32_bf16 v248, v154, v154, v248
v_dot2_f32_bf16 v250, v154, v228, v250
v_dot2_f32_bf16 v248, v155, v155, v248
v_dot2_f32_bf16 v250, v155, v228, v250
v_dot2_f32_bf16 v248, v160, v160, v248
v_dot2_f32_bf16 v250, v160, v228, v250
v_dot2_f32_bf16 v248, v161, v161, v248
v_dot2_f32_bf16 v250, v161, v228, v250
v_dot2_f32_bf16 v248, v162, v162, v248
v_dot2_f32_bf16 v250, v162, v228, v250
v_dot2_f32_bf16 v248, v163, v163, v248
v_dot2_f32_bf16 v250, v163, v228, v250
s_setprio 3
s_waitcnt lgkmcnt(6)
v_mfma_f32_16x16x32_bf16 v[216:219], v[0:3], v[192:195], 0
v_mfma_f32_16x16x32_bf16 v[220:223], v[24:27], v[192:195], 0
v_mfma_f32_16x16x32_bf16 v[224:227], v[48:51], v[192:195], 0
v_mfma_f32_16x16x32_bf16 v[216:219], v[4:7], v[196:199], v[216:219]
v_mfma_f32_16x16x32_bf16 v[220:223], v[28:31], v[196:199], v[220:223]
v_mfma_f32_16x16x32_bf16 v[224:227], v[52:55], v[196:199], v[224:227]
v_mfma_f32_16x16x32_bf16 v[216:219], v[8:11], v[200:203], v[216:219]
v_mfma_f32_16x16x32_bf16 v[220:223], v[32:35], v[200:203], v[220:223]
v_mfma_f32_16x16x32_bf16 v[224:227], v[56:59], v[200:203], v[224:227]
v_mfma_f32_16x16x32_bf16 v[216:219], v[12:15], v[204:207], v[216:219]
v_mfma_f32_16x16x32_bf16 v[220:223], v[36:39], v[204:207], v[220:223]
v_add_f32_dpp v249, v249, v249 row_half_mirror row_mask:0xf bank_mask:0xa
v_add_f32_dpp v251, v251, v251 row_half_mirror row_mask:0xf bank_mask:0xa
v_mfma_f32_16x16x32_bf16 v[224:227], v[60:63], v[204:207], v[224:227]
v_add_f32_dpp v249, v248, v248 row_half_mirror row_mask:0xf bank_mask:0x5
v_add_f32_dpp v251, v250, v250 row_half_mirror row_mask:0xf bank_mask:0x5
v_mfma_f32_16x16x32_bf16 v[216:219], v[16:19], v[208:211], v[216:219]
v_add_f32_dpp v249, v249, v249 quad_perm:[1,0,3,2] row_mask:0xf bank_mask:0xf
v_add_f32_dpp v251, v251, v251 quad_perm:[1,0,3,2] row_mask:0xf bank_mask:0xf
v_mfma_f32_16x16x32_bf16 v[220:223], v[40:43], v[208:211], v[220:223]
v_add_f32_dpp v249, v249, v249 quad_perm:[2,3,0,1] row_mask:0xf bank_mask:0xf
v_add_f32_dpp v251, v251, v251 quad_perm:[2,3,0,1] row_mask:0xf bank_mask:0xf
v_mfma_f32_16x16x32_bf16 v[224:227], v[64:67], v[208:211], v[224:227]
v_mul_f32 v172, s34, v251
v_fma_f32 v173, -v172, v172, s35
v_mfma_f32_16x16x32_bf16 v[216:219], v[20:23], v[212:215], v[216:219]
v_cvt_pk_bf16_f32 v174, v172, v172
v_fma_f32 v248, v249, s34, v173
v_mfma_f32_16x16x32_bf16 v[220:223], v[44:47], v[212:215], v[220:223]
v_and_b32 v175, 0xffff0000, v174
v_max_f32 v248, s35, v248
v_mfma_f32_16x16x32_bf16 v[224:227], v[68:71], v[212:215], v[224:227]
v_sub_f32 v172, v172, v175
v_rsq_f32 v248, v248
v_cvt_pk_bf16_f32 v175, v175, v172
PJ9:
s_mov_b64 exec, s[0:1]
ds_write2st64_b32 v245, v175, v174 offset0:1 offset1:2
ds_write_b32 v245, v248
s_mov_b64 exec, -1
v_add_u32 v245, s28, v245
ds_write_b128 v237, v[216:219] offset:0
ds_write_b128 v238, v[220:223] offset:0
ds_write_b128 v239, v[224:227] offset:0
v_add_u32 v237, s36, v237
v_add_u32 v238, s36, v238
v_add_u32 v239, s36, v239
s_setprio 0
s_cmp_eq_u32 s27, 2
s_cbranch_scc1 PN_sync
PN_syncr:
ds_read_b128 v[144:147], v240 offset:0
ds_read_b128 v[148:151], v240 offset:6144
ds_read_b128 v[152:155], v240 offset:128
ds_read_b128 v[156:159], v240 offset:6272
ds_read_b128 v[160:163], v240 offset:256
ds_read_b128 v[164:167], v240 offset:6400
v_subrev_u32 v240, s36, v240
ds_read_b128 v[192:195], v235 offset:0
ds_read_b128 v[196:199], v236 offset:0
ds_read_b128 v[200:203], v235 offset:128
ds_read_b128 v[204:207], v236 offset:128
ds_read_b128 v[208:211], v235 offset:256
ds_read_b128 v[212:215], v236 offset:256
s_add_u32 s38, s38, 1
s_and_b32 s38, s38, 3
s_cmp_eq_u32 s38, 0
s_cselect_b32 s30, 0xffffb800, s46
v_add_u32 v235, s30, v235
v_add_u32 v236, s30, v236
s_sub_u32 s36, 0, s36
s_cmp_lt_u32 s27, s18
s_cbranch_scc1 PN_l1
PN_lr1:
s_and_b32 s32, s31, 3
s_mul_i32 s32, s32, 6144
s_add_u32 m0, s32, s33
s_add_u32 s31, s31, 1
s_cmp_le_u32 s31, 16
s_cselect_b32 s14, s14, 0
s_mov_b64 exec, s[42:43]
buffer_load_dwordx4 v246, s[12:15], s29 offen nt lds
buffer_load_dwordx4 v247, s[12:15], s29 offen offset:768 nt lds
s_mov_b64 exec, -1
s_add_u32 s29, s29, 6144
s_waitcnt vmcnt(16) lgkmcnt(12)
s_setprio 3
s_barrier
s_waitcnt lgkmcnt(6)
v_mfma_f32_16x16x16_bf16 v[168:171], v[232:233], v[132:133], v[144:147]
v_mfma_f32_16x16x16_bf16 v[172:175], v[232:233], v[134:135], v[148:151]
v_mfma_f32_16x16x16_bf16 v[176:179], v[232:233], v[136:137], v[152:155]
v_mfma_f32_16x16x16_bf16 v[180:183], v[232:233], v[138:139], v[156:159]
v_mfma_f32_16x16x16_bf16 v[184:187], v[232:233], v[140:141], v[160:163]
v_mfma_f32_16x16x16_bf16 v[188:191], v[232:233], v[142:143], v[164:167]
s_mov_b32 s40, s26
s_add_u32 s41, s26, 196608
s_add_u32 s26, s26, 12288
v_mfma_f32_16x16x16_bf16 v[144:147], v[232:233], v[120:121], v[144:147]
v_cvt_pk_bf16_f32 v168, v168, v169
v_cvt_pk_bf16_f32 v169, v170, v171
v_cvt_pk_bf16_f32 v170, v172, v173
v_cvt_pk_bf16_f32 v171, v174, v175
v_mfma_f32_16x16x16_bf16 v[148:151], v[232:233], v[122:123], v[148:151]
v_cvt_pk_bf16_f32 v176, v176, v177
v_cvt_pk_bf16_f32 v177, v178, v179
v_cvt_pk_bf16_f32 v178, v180, v181
v_cvt_pk_bf16_f32 v179, v182, v183
v_mfma_f32_16x16x16_bf16 v[152:155], v[232:233], v[124:125], v[152:155]
v_cvt_pk_bf16_f32 v184, v184, v185
v_cvt_pk_bf16_f32 v185, v186, v187
v_cvt_pk_bf16_f32 v186, v188, v189
v_cvt_pk_bf16_f32 v187, v190, v191
v_mfma_f32_16x16x16_bf16 v[156:159], v[232:233], v[126:127], v[156:159]
v_mfma_f32_16x16x16_bf16 v[160:163], v[232:233], v[128:129], v[160:163]
v_mfma_f32_16x16x16_bf16 v[164:167], v[232:233], v[130:131], v[164:167]
s_setprio 0
s_cmp_lt_u32 s27, s17
ds_write_b128 v242, v[168:171] offset:0
s_cbranch_scc1 PK10
buffer_load_dwordx4 v[132:135], v234, s[8:11], s41 offen offset:0 nt
PK10:
v_cvt_pk_bf16_f32 v144, v144, v145
v_cvt_pk_bf16_f32 v145, v146, v147
v_cvt_pk_bf16_f32 v146, v148, v149
v_cvt_pk_bf16_f32 v147, v150, v151
ds_write_b128 v242, v[176:179] offset:128
s_cbranch_scc1 PK11
buffer_load_dwordx4 v[136:139], v234, s[8:11], s41 offen offset:128 nt
PK11:
v_cvt_pk_bf16_f32 v152, v152, v153
v_cvt_pk_bf16_f32 v153, v154, v155
v_cvt_pk_bf16_f32 v154, v156, v157
v_cvt_pk_bf16_f32 v155, v158, v159
ds_write_b128 v242, v[184:187] offset:256
s_cbranch_scc1 PK12
buffer_load_dwordx4 v[140:143], v234, s[8:11], s41 offen offset:256 nt
PK12:
v_cvt_pk_bf16_f32 v160, v160, v161
v_cvt_pk_bf16_f32 v161, v162, v163
v_cvt_pk_bf16_f32 v162, v164, v165
v_cvt_pk_bf16_f32 v163, v166, v167
ds_write_b128 v241, v[144:147] offset:0
s_cbranch_scc1 PK13
buffer_load_dwordx4 v[120:123], v234, s[8:11], s40 offen offset:0 nt
PK13:
ds_write_b128 v241, v[152:155] offset:128
s_cbranch_scc1 PK14
buffer_load_dwordx4 v[124:127], v234, s[8:11], s40 offen offset:128 nt
PK14:
ds_write_b128 v241, v[160:163] offset:256
s_cbranch_scc1 PK15
buffer_load_dwordx4 v[128:131], v234, s[8:11], s40 offen offset:256 nt
PK15:
s_setprio 0
s_add_u32 s27, s27, 1
s_and_b32 s28, s27, 3
s_cmp_eq_u32 s28, 0
s_cselect_b32 s28, 0xfffed700, s47
v_add_u32 v241, s28, v241
v_add_u32 v242, s28, v242
s_cmp_lt_u32 s16, 128
s_cbranch_scc1 PA16
s_setprio 3
s_waitcnt lgkmcnt(6)
v_mfma_f32_16x16x32_bf16 v[216:219], v[0:3], v[192:195], 0
v_dot2_f32_bf16 v249, v168, v168, 0
v_dot2_f32_bf16 v251, v168, v228, 0
v_mfma_f32_16x16x32_bf16 v[220:223], v[24:27], v[192:195], 0
v_dot2_f32_bf16 v249, v169, v169, v249
v_dot2_f32_bf16 v251, v169, v228, v251
v_mfma_f32_16x16x32_bf16 v[224:227], v[48:51], v[192:195], 0
v_dot2_f32_bf16 v249, v170, v170, v249
v_dot2_f32_bf16 v251, v170, v228, v251
v_mfma_f32_16x16x32_bf16 v[216:219], v[4:7], v[196:199], v[216:219]
v_dot2_f32_bf16 v249, v171, v171, v249
v_dot2_f32_bf16 v251, v171, v228, v251
v_mfma_f32_16x16x32_bf16 v[220:223], v[28:31], v[196:199], v[220:223]
v_dot2_f32_bf16 v249, v176, v176, v249
v_dot2_f32_bf16 v251, v176, v228, v251
v_mfma_f32_16x16x32_bf16 v[224:227], v[52:55], v[196:199], v[224:227]
v_dot2_f32_bf16 v249, v177, v177, v249
v_dot2_f32_bf16 v251, v177, v228, v251
v_mfma_f32_16x16x32_bf16 v[216:219], v[8:11], v[200:203], v[216:219]
v_dot2_f32_bf16 v249, v178, v178, v249
v_dot2_f32_bf16 v251, v178, v228, v251
v_mfma_f32_16x16x32_bf16 v[220:223], v[32:35], v[200:203], v[220:223]
v_dot2_f32_bf16 v249, v179, v179, v249
v_dot2_f32_bf16 v251, v179, v228, v251
v_mfma_f32_16x16x32_bf16 v[224:227], v[56:59], v[200:203], v[224:227]
v_dot2_f32_bf16 v249, v184, v184, v249
v_dot2_f32_bf16 v251, v184, v228, v251
v_mfma_f32_16x16x32_bf16 v[216:219], v[12:15], v[204:207], v[216:219]
v_dot2_f32_bf16 v249, v185, v185, v249
v_dot2_f32_bf16 v251, v185, v228, v251
v_mfma_f32_16x16x32_bf16 v[220:223], v[36:39], v[204:207], v[220:223]
v_dot2_f32_bf16 v249, v186, v186, v249
v_dot2_f32_bf16 v251, v186, v228, v251
v_mfma_f32_16x16x32_bf16 v[224:227], v[60:63], v[204:207], v[224:227]
v_dot2_f32_bf16 v249, v187, v187, v249
v_dot2_f32_bf16 v251, v187, v228, v251
v_mfma_f32_16x16x32_bf16 v[216:219], v[16:19], v[208:211], v[216:219]
v_dot2_f32_bf16 v248, v144, v144, 0
v_dot2_f32_bf16 v250, v144, v228, 0
v_mfma_f32_16x16x32_bf16 v[220:223], v[40:43], v[208:211], v[220:223]
v_dot2_f32_bf16 v248, v145, v145, v248
v_dot2_f32_bf16 v250, v145, v228, v250
v_mfma_f32_16x16x32_bf16 v[224:227], v[64:67], v[208:211], v[224:227]
v_dot2_f32_bf16 v248, v146, v146, v248
v_dot2_f32_bf16 v250, v146, v228, v250
v_mfma_f32_16x16x32_bf16 v[216:219], v[20:23], v[212:215], v[216:219]
v_dot2_f32_bf16 v248, v147, v147, v248
v_dot2_f32_bf16 v250, v147, v228, v250
v_dot2_f32_bf16 v248, v152, v152, v248
v_dot2_f32_bf16 v250, v152, v228, v250
v_dot2_f32_bf16 v248, v153, v153, v248
v_dot2_f32_bf16 v250, v153, v228, v250
v_dot2_f32_bf16 v248, v154, v154, v248
v_dot2_f32_bf16 v250, v154, v228, v250
v_dot2_f32_bf16 v248, v155, v155, v248
v_dot2_f32_bf16 v250, v155, v228, v250
v_dot2_f32_bf16 v248, v160, v160, v248
v_dot2_f32_bf16 v250, v160, v228, v250
v_dot2_f32_bf16 v248, v161, v161, v248
v_dot2_f32_bf16 v250, v161, v228, v250
v_dot2_f32_bf16 v248, v162, v162, v248
v_dot2_f32_bf16 v250, v162, v228, v250
v_dot2_f32_bf16 v248, v163, v163, v248
v_dot2_f32_bf16 v250, v163, v228, v250
v_add_f32_dpp v249, v249, v249 row_half_mirror row_mask:0xf bank_mask:0xa
v_add_f32_dpp v251, v251, v251 row_half_mirror row_mask:0xf bank_mask:0xa
v_mfma_f32_16x16x32_bf16 v[220:223], v[44:47], v[212:215], v[220:223]
v_add_f32_dpp v249, v248, v248 row_half_mirror row_mask:0xf bank_mask:0x5
v_add_f32_dpp v251, v250, v250 row_half_mirror row_mask:0xf bank_mask:0x5
s_nop 0
v_add_f32_dpp v249, v249, v249 quad_perm:[1,0,3,2] row_mask:0xf bank_mask:0xf
v_add_f32_dpp v251, v251, v251 quad_perm:[1,0,3,2] row_mask:0xf bank_mask:0xf
v_mfma_f32_16x16x32_bf16 v[224:227], v[68:71], v[212:215], v[224:227]
v_add_f32_dpp v249, v249, v249 quad_perm:[2,3,0,1] row_mask:0xf bank_mask:0xf
v_add_f32_dpp v251, v251, v251 quad_perm:[2,3,0,1] row_mask:0xf bank_mask:0xf
v_mul_f32 v172, s34, v251
v_fma_f32 v173, -v172, v172, s35
v_cvt_pk_bf16_f32 v174, v172, v172
v_fma_f32 v248, v249, s34, v173
v_and_b32 v175, 0xffff0000, v174
v_max_f32 v248, s35, v248
v_sub_f32 v172, v172, v175
v_rsq_f32 v248, v248
v_cvt_pk_bf16_f32 v175, v175, v172
s_branch PJ16
PA16:
v_dot2_f32_bf16 v249, v168, v168, 0
v_dot2_f32_bf16 v251, v168, v228, 0
v_dot2_f32_bf16 v249, v169, v169, v249
v_dot2_f32_bf16 v251, v169, v228, v251
v_dot2_f32_bf16 v249, v170, v170, v249
v_dot2_f32_bf16 v251, v170, v228, v251
v_dot2_f32_bf16 v249, v171, v171, v249
v_dot2_f32_bf16 v251, v171, v228, v251
v_dot2_f32_bf16 v249, v176, v176, v249
v_dot2_f32_bf16 v251, v176, v228, v251
v_dot2_f32_bf16 v249, v177, v177, v249
v_dot2_f32_bf16 v251, v177, v228, v251
v_dot2_f32_bf16 v249, v178, v178, v249
v_dot2_f32_bf16 v251, v178, v228, v251
v_dot2_f32_bf16 v249, v179, v179, v249
v_dot2_f32_bf16 v251, v179, v228, v251
v_dot2_f32_bf16 v249, v184, v184, v249
v_dot2_f32_bf16 v251, v184, v228, v251
v_dot2_f32_bf16 v249, v185, v185, v249
v_dot2_f32_bf16 v251, v185, v228, v251
v_dot2_f32_bf16 v249, v186, v186, v249
v_dot2_f32_bf16 v251, v186, v228, v251
v_dot2_f32_bf16 v249, v187, v187, v249
v_dot2_f32_bf16 v251, v187, v228, v251
v_dot2_f32_bf16 v248, v144, v144, 0
v_dot2_f32_bf16 v250, v144, v228, 0
v_dot2_f32_bf16 v248, v145, v145, v248
v_dot2_f32_bf16 v250, v145, v228, v250
v_dot2_f32_bf16 v248, v146, v146, v248
v_dot2_f32_bf16 v250, v146, v228, v250
v_dot2_f32_bf16 v248, v147, v147, v248
v_dot2_f32_bf16 v250, v147, v228, v250
v_dot2_f32_bf16 v248, v152, v152, v248
v_dot2_f32_bf16 v250, v152, v228, v250
v_dot2_f32_bf16 v248, v153, v153, v248
v_dot2_f32_bf16 v250, v153, v228, v250
v_dot2_f32_bf16 v248, v154, v154, v248
v_dot2_f32_bf16 v250, v154, v228, v250
v_dot2_f32_bf16 v248, v155, v155, v248
v_dot2_f32_bf16 v250, v155, v228, v250
v_dot2_f32_bf16 v248, v160, v160, v248
v_dot2_f32_bf16 v250, v160, v228, v250
v_dot2_f32_bf16 v248, v161, v161, v248
v_dot2_f32_bf16 v250, v161, v228, v250
v_dot2_f32_bf16 v248, v162, v162, v248
v_dot2_f32_bf16 v250, v162, v228, v250
v_dot2_f32_bf16 v248, v163, v163, v248
v_dot2_f32_bf16 v250, v163, v228, v250
s_setprio 3
s_waitcnt lgkmcnt(6)
v_mfma_f32_16x16x32_bf16 v[216:219], v[0:3], v[192:195], 0
v_mfma_f32_16x16x32_bf16 v[220:223], v[24:27], v[192:195], 0
v_mfma_f32_16x16x32_bf16 v[224:227], v[48:51], v[192:195], 0
v_mfma_f32_16x16x32_bf16 v[216:219], v[4:7], v[196:199], v[216:219]
v_mfma_f32_16x16x32_bf16 v[220:223], v[28:31], v[196:199], v[220:223]
v_mfma_f32_16x16x32_bf16 v[224:227], v[52:55], v[196:199], v[224:227]
v_mfma_f32_16x16x32_bf16 v[216:219], v[8:11], v[200:203], v[216:219]
v_mfma_f32_16x16x32_bf16 v[220:223], v[32:35], v[200:203], v[220:223]
v_mfma_f32_16x16x32_bf16 v[224:227], v[56:59], v[200:203], v[224:227]
v_mfma_f32_16x16x32_bf16 v[216:219], v[12:15], v[204:207], v[216:219]
v_mfma_f32_16x16x32_bf16 v[220:223], v[36:39], v[204:207], v[220:223]
v_add_f32_dpp v249, v249, v249 row_half_mirror row_mask:0xf bank_mask:0xa
v_add_f32_dpp v251, v251, v251 row_half_mirror row_mask:0xf bank_mask:0xa
v_mfma_f32_16x16x32_bf16 v[224:227], v[60:63], v[204:207], v[224:227]
v_add_f32_dpp v249, v248, v248 row_half_mirror row_mask:0xf bank_mask:0x5
v_add_f32_dpp v251, v250, v250 row_half_mirror row_mask:0xf bank_mask:0x5
v_mfma_f32_16x16x32_bf16 v[216:219], v[16:19], v[208:211], v[216:219]
v_add_f32_dpp v249, v249, v249 quad_perm:[1,0,3,2] row_mask:0xf bank_mask:0xf
v_add_f32_dpp v251, v251, v251 quad_perm:[1,0,3,2] row_mask:0xf bank_mask:0xf
v_mfma_f32_16x16x32_bf16 v[220:223], v[40:43], v[208:211], v[220:223]
v_add_f32_dpp v249, v249, v249 quad_perm:[2,3,0,1] row_mask:0xf bank_mask:0xf
v_add_f32_dpp v251, v251, v251 quad_perm:[2,3,0,1] row_mask:0xf bank_mask:0xf
v_mfma_f32_16x16x32_bf16 v[224:227], v[64:67], v[208:211], v[224:227]
v_mul_f32 v172, s34, v251
v_fma_f32 v173, -v172, v172, s35
v_mfma_f32_16x16x32_bf16 v[216:219], v[20:23], v[212:215], v[216:219]
v_cvt_pk_bf16_f32 v174, v172, v172
v_fma_f32 v248, v249, s34, v173
v_mfma_f32_16x16x32_bf16 v[220:223], v[44:47], v[212:215], v[220:223]
v_and_b32 v175, 0xffff0000, v174
v_max_f32 v248, s35, v248
v_mfma_f32_16x16x32_bf16 v[224:227], v[68:71], v[212:215], v[224:227]
v_sub_f32 v172, v172, v175
v_rsq_f32 v248, v248
v_cvt_pk_bf16_f32 v175, v175, v172
PJ16:
s_mov_b64 exec, s[0:1]
ds_write2st64_b32 v245, v175, v174 offset0:1 offset1:2
ds_write_b32 v245, v248
s_mov_b64 exec, -1
v_add_u32 v245, s28, v245
ds_write_b128 v237, v[216:219] offset:0
ds_write_b128 v238, v[220:223] offset:0
ds_write_b128 v239, v[224:227] offset:0
v_add_u32 v237, s36, v237
v_add_u32 v238, s36, v238
v_add_u32 v239, s36, v239
s_setprio 0
ds_read_b128 v[144:147], v240 offset:0
ds_read_b128 v[148:151], v240 offset:6144
ds_read_b128 v[152:155], v240 offset:128
ds_read_b128 v[156:159], v240 offset:6272
ds_read_b128 v[160:163], v240 offset:256
ds_read_b128 v[164:167], v240 offset:6400
v_subrev_u32 v240, s36, v240
ds_read_b128 v[192:195], v235 offset:0
ds_read_b128 v[196:199], v236 offset:0
ds_read_b128 v[200:203], v235 offset:128
ds_read_b128 v[204:207], v236 offset:128
ds_read_b128 v[208:211], v235 offset:256
ds_read_b128 v[212:215], v236 offset:256
s_add_u32 s38, s38, 1
s_and_b32 s38, s38, 3
s_cmp_eq_u32 s38, 0
s_cselect_b32 s30, 0xffffb800, s46
v_add_u32 v235, s30, v235
v_add_u32 v236, s30, v236
s_sub_u32 s36, 0, s36
s_cmp_lt_u32 s27, s18
s_cbranch_scc1 PN_l2
PN_lr2:
s_and_b32 s32, s31, 3
s_mul_i32 s32, s32, 6144
s_add_u32 m0, s32, s33
s_add_u32 s31, s31, 1
s_cmp_le_u32 s31, 16
s_cselect_b32 s14, s14, 0
s_mov_b64 exec, s[42:43]
buffer_load_dwordx4 v246, s[12:15], s29 offen nt lds
buffer_load_dwordx4 v247, s[12:15], s29 offen offset:768 nt lds
s_mov_b64 exec, -1
s_add_u32 s29, s29, 6144
s_waitcnt vmcnt(16) lgkmcnt(12)
s_setprio 3
s_barrier
s_waitcnt lgkmcnt(6)
v_mfma_f32_16x16x16_bf16 v[168:171], v[232:233], v[84:85], v[144:147]
v_mfma_f32_16x16x16_bf16 v[172:175], v[232:233], v[86:87], v[148:151]
v_mfma_f32_16x16x16_bf16 v[176:179], v[232:233], v[88:89], v[152:155]
v_mfma_f32_16x16x16_bf16 v[180:183], v[232:233], v[90:91], v[156:159]
v_mfma_f32_16x16x16_bf16 v[184:187], v[232:233], v[92:93], v[160:163]
v_mfma_f32_16x16x16_bf16 v[188:191], v[232:233], v[94:95], v[164:167]
s_mov_b32 s40, s26
s_add_u32 s41, s26, 196608
s_add_u32 s26, s26, 12288
v_mfma_f32_16x16x16_bf16 v[144:147], v[232:233], v[72:73], v[144:147]
v_cvt_pk_bf16_f32 v168, v168, v169
v_cvt_pk_bf16_f32 v169, v170, v171
v_cvt_pk_bf16_f32 v170, v172, v173
v_cvt_pk_bf16_f32 v171, v174, v175
v_mfma_f32_16x16x16_bf16 v[148:151], v[232:233], v[74:75], v[148:151]
v_cvt_pk_bf16_f32 v176, v176, v177
v_cvt_pk_bf16_f32 v177, v178, v179
v_cvt_pk_bf16_f32 v178, v180, v181
v_cvt_pk_bf16_f32 v179, v182, v183
v_mfma_f32_16x16x16_bf16 v[152:155], v[232:233], v[76:77], v[152:155]
v_cvt_pk_bf16_f32 v184, v184, v185
v_cvt_pk_bf16_f32 v185, v186, v187
v_cvt_pk_bf16_f32 v186, v188, v189
v_cvt_pk_bf16_f32 v187, v190, v191
v_mfma_f32_16x16x16_bf16 v[156:159], v[232:233], v[78:79], v[156:159]
v_mfma_f32_16x16x16_bf16 v[160:163], v[232:233], v[80:81], v[160:163]
v_mfma_f32_16x16x16_bf16 v[164:167], v[232:233], v[82:83], v[164:167]
s_setprio 0
s_cmp_lt_u32 s27, s17
ds_write_b128 v242, v[168:171] offset:0
s_cbranch_scc1 PK17
buffer_load_dwordx4 v[84:87], v234, s[8:11], s41 offen offset:0 nt
PK17:
v_cvt_pk_bf16_f32 v144, v144, v145
v_cvt_pk_bf16_f32 v145, v146, v147
v_cvt_pk_bf16_f32 v146, v148, v149
v_cvt_pk_bf16_f32 v147, v150, v151
ds_write_b128 v242, v[176:179] offset:128
s_cbranch_scc1 PK18
buffer_load_dwordx4 v[88:91], v234, s[8:11], s41 offen offset:128 nt
PK18:
v_cvt_pk_bf16_f32 v152, v152, v153
v_cvt_pk_bf16_f32 v153, v154, v155
v_cvt_pk_bf16_f32 v154, v156, v157
v_cvt_pk_bf16_f32 v155, v158, v159
ds_write_b128 v242, v[184:187] offset:256
s_cbranch_scc1 PK19
buffer_load_dwordx4 v[92:95], v234, s[8:11], s41 offen offset:256 nt
PK19:
v_cvt_pk_bf16_f32 v160, v160, v161
v_cvt_pk_bf16_f32 v161, v162, v163
v_cvt_pk_bf16_f32 v162, v164, v165
v_cvt_pk_bf16_f32 v163, v166, v167
ds_write_b128 v241, v[144:147] offset:0
s_cbranch_scc1 PK20
buffer_load_dwordx4 v[72:75], v234, s[8:11], s40 offen offset:0 nt
PK20:
ds_write_b128 v241, v[152:155] offset:128
s_cbranch_scc1 PK21
buffer_load_dwordx4 v[76:79], v234, s[8:11], s40 offen offset:128 nt
PK21:
ds_write_b128 v241, v[160:163] offset:256
s_cbranch_scc1 PK22
buffer_load_dwordx4 v[80:83], v234, s[8:11], s40 offen offset:256 nt
PK22:
s_setprio 0
s_add_u32 s27, s27, 1
s_and_b32 s28, s27, 3
s_cmp_eq_u32 s28, 0
s_cselect_b32 s28, 0xfffed700, s47
v_add_u32 v241, s28, v241
v_add_u32 v242, s28, v242
s_cmp_lt_u32 s16, 128
s_cbranch_scc1 PA23
s_setprio 3
s_waitcnt lgkmcnt(6)
v_mfma_f32_16x16x32_bf16 v[216:219], v[0:3], v[192:195], 0
v_dot2_f32_bf16 v249, v168, v168, 0
v_dot2_f32_bf16 v251, v168, v228, 0
v_mfma_f32_16x16x32_bf16 v[220:223], v[24:27], v[192:195], 0
v_dot2_f32_bf16 v249, v169, v169, v249
v_dot2_f32_bf16 v251, v169, v228, v251
v_mfma_f32_16x16x32_bf16 v[224:227], v[48:51], v[192:195], 0
v_dot2_f32_bf16 v249, v170, v170, v249
v_dot2_f32_bf16 v251, v170, v228, v251
v_mfma_f32_16x16x32_bf16 v[216:219], v[4:7], v[196:199], v[216:219]
v_dot2_f32_bf16 v249, v171, v171, v249
v_dot2_f32_bf16 v251, v171, v228, v251
v_mfma_f32_16x16x32_bf16 v[220:223], v[28:31], v[196:199], v[220:223]
v_dot2_f32_bf16 v249, v176, v176, v249
v_dot2_f32_bf16 v251, v176, v228, v251
v_mfma_f32_16x16x32_bf16 v[224:227], v[52:55], v[196:199], v[224:227]
v_dot2_f32_bf16 v249, v177, v177, v249
v_dot2_f32_bf16 v251, v177, v228, v251
v_mfma_f32_16x16x32_bf16 v[216:219], v[8:11], v[200:203], v[216:219]
v_dot2_f32_bf16 v249, v178, v178, v249
v_dot2_f32_bf16 v251, v178, v228, v251
v_mfma_f32_16x16x32_bf16 v[220:223], v[32:35], v[200:203], v[220:223]
v_dot2_f32_bf16 v249, v179, v179, v249
v_dot2_f32_bf16 v251, v179, v228, v251
v_mfma_f32_16x16x32_bf16 v[224:227], v[56:59], v[200:203], v[224:227]
v_dot2_f32_bf16 v249, v184, v184, v249
v_dot2_f32_bf16 v251, v184, v228, v251
v_mfma_f32_16x16x32_bf16 v[216:219], v[12:15], v[204:207], v[216:219]
v_dot2_f32_bf16 v249, v185, v185, v249
v_dot2_f32_bf16 v251, v185, v228, v251
v_mfma_f32_16x16x32_bf16 v[220:223], v[36:39], v[204:207], v[220:223]
v_dot2_f32_bf16 v249, v186, v186, v249
v_dot2_f32_bf16 v251, v186, v228, v251
v_mfma_f32_16x16x32_bf16 v[224:227], v[60:63], v[204:207], v[224:227]
v_dot2_f32_bf16 v249, v187, v187, v249
v_dot2_f32_bf16 v251, v187, v228, v251
v_mfma_f32_16x16x32_bf16 v[216:219], v[16:19], v[208:211], v[216:219]
v_dot2_f32_bf16 v248, v144, v144, 0
v_dot2_f32_bf16 v250, v144, v228, 0
v_mfma_f32_16x16x32_bf16 v[220:223], v[40:43], v[208:211], v[220:223]
v_dot2_f32_bf16 v248, v145, v145, v248
v_dot2_f32_bf16 v250, v145, v228, v250
v_mfma_f32_16x16x32_bf16 v[224:227], v[64:67], v[208:211], v[224:227]
v_dot2_f32_bf16 v248, v146, v146, v248
v_dot2_f32_bf16 v250, v146, v228, v250
v_mfma_f32_16x16x32_bf16 v[216:219], v[20:23], v[212:215], v[216:219]
v_dot2_f32_bf16 v248, v147, v147, v248
v_dot2_f32_bf16 v250, v147, v228, v250
v_dot2_f32_bf16 v248, v152, v152, v248
v_dot2_f32_bf16 v250, v152, v228, v250
v_dot2_f32_bf16 v248, v153, v153, v248
v_dot2_f32_bf16 v250, v153, v228, v250
v_dot2_f32_bf16 v248, v154, v154, v248
v_dot2_f32_bf16 v250, v154, v228, v250
v_dot2_f32_bf16 v248, v155, v155, v248
v_dot2_f32_bf16 v250, v155, v228, v250
v_dot2_f32_bf16 v248, v160, v160, v248
v_dot2_f32_bf16 v250, v160, v228, v250
v_dot2_f32_bf16 v248, v161, v161, v248
v_dot2_f32_bf16 v250, v161, v228, v250
v_dot2_f32_bf16 v248, v162, v162, v248
v_dot2_f32_bf16 v250, v162, v228, v250
v_dot2_f32_bf16 v248, v163, v163, v248
v_dot2_f32_bf16 v250, v163, v228, v250
v_add_f32_dpp v249, v249, v249 row_half_mirror row_mask:0xf bank_mask:0xa
v_add_f32_dpp v251, v251, v251 row_half_mirror row_mask:0xf bank_mask:0xa
v_mfma_f32_16x16x32_bf16 v[220:223], v[44:47], v[212:215], v[220:223]
v_add_f32_dpp v249, v248, v248 row_half_mirror row_mask:0xf bank_mask:0x5
v_add_f32_dpp v251, v250, v250 row_half_mirror row_mask:0xf bank_mask:0x5
s_nop 0
v_add_f32_dpp v249, v249, v249 quad_perm:[1,0,3,2] row_mask:0xf bank_mask:0xf
v_add_f32_dpp v251, v251, v251 quad_perm:[1,0,3,2] row_mask:0xf bank_mask:0xf
v_mfma_f32_16x16x32_bf16 v[224:227], v[68:71], v[212:215], v[224:227]
v_add_f32_dpp v249, v249, v249 quad_perm:[2,3,0,1] row_mask:0xf bank_mask:0xf
v_add_f32_dpp v251, v251, v251 quad_perm:[2,3,0,1] row_mask:0xf bank_mask:0xf
v_mul_f32 v172, s34, v251
v_fma_f32 v173, -v172, v172, s35
v_cvt_pk_bf16_f32 v174, v172, v172
v_fma_f32 v248, v249, s34, v173
v_and_b32 v175, 0xffff0000, v174
v_max_f32 v248, s35, v248
v_sub_f32 v172, v172, v175
v_rsq_f32 v248, v248
v_cvt_pk_bf16_f32 v175, v175, v172
s_branch PJ23
PA23:
v_dot2_f32_bf16 v249, v168, v168, 0
v_dot2_f32_bf16 v251, v168, v228, 0
v_dot2_f32_bf16 v249, v169, v169, v249
v_dot2_f32_bf16 v251, v169, v228, v251
v_dot2_f32_bf16 v249, v170, v170, v249
v_dot2_f32_bf16 v251, v170, v228, v251
v_dot2_f32_bf16 v249, v171, v171, v249
v_dot2_f32_bf16 v251, v171, v228, v251
v_dot2_f32_bf16 v249, v176, v176, v249
v_dot2_f32_bf16 v251, v176, v228, v251
v_dot2_f32_bf16 v249, v177, v177, v249
v_dot2_f32_bf16 v251, v177, v228, v251
v_dot2_f32_bf16 v249, v178, v178, v249
v_dot2_f32_bf16 v251, v178, v228, v251
v_dot2_f32_bf16 v249, v179, v179, v249
v_dot2_f32_bf16 v251, v179, v228, v251
v_dot2_f32_bf16 v249, v184, v184, v249
v_dot2_f32_bf16 v251, v184, v228, v251
v_dot2_f32_bf16 v249, v185, v185, v249
v_dot2_f32_bf16 v251, v185, v228, v251
v_dot2_f32_bf16 v249, v186, v186, v249
v_dot2_f32_bf16 v251, v186, v228, v251
v_dot2_f32_bf16 v249, v187, v187, v249
v_dot2_f32_bf16 v251, v187, v228, v251
v_dot2_f32_bf16 v248, v144, v144, 0
v_dot2_f32_bf16 v250, v144, v228, 0
v_dot2_f32_bf16 v248, v145, v145, v248
v_dot2_f32_bf16 v250, v145, v228, v250
v_dot2_f32_bf16 v248, v146, v146, v248
v_dot2_f32_bf16 v250, v146, v228, v250
v_dot2_f32_bf16 v248, v147, v147, v248
v_dot2_f32_bf16 v250, v147, v228, v250
v_dot2_f32_bf16 v248, v152, v152, v248
v_dot2_f32_bf16 v250, v152, v228, v250
v_dot2_f32_bf16 v248, v153, v153, v248
v_dot2_f32_bf16 v250, v153, v228, v250
v_dot2_f32_bf16 v248, v154, v154, v248
v_dot2_f32_bf16 v250, v154, v228, v250
v_dot2_f32_bf16 v248, v155, v155, v248
v_dot2_f32_bf16 v250, v155, v228, v250
v_dot2_f32_bf16 v248, v160, v160, v248
v_dot2_f32_bf16 v250, v160, v228, v250
v_dot2_f32_bf16 v248, v161, v161, v248
v_dot2_f32_bf16 v250, v161, v228, v250
v_dot2_f32_bf16 v248, v162, v162, v248
v_dot2_f32_bf16 v250, v162, v228, v250
v_dot2_f32_bf16 v248, v163, v163, v248
v_dot2_f32_bf16 v250, v163, v228, v250
s_setprio 3
s_waitcnt lgkmcnt(6)
v_mfma_f32_16x16x32_bf16 v[216:219], v[0:3], v[192:195], 0
v_mfma_f32_16x16x32_bf16 v[220:223], v[24:27], v[192:195], 0
v_mfma_f32_16x16x32_bf16 v[224:227], v[48:51], v[192:195], 0
v_mfma_f32_16x16x32_bf16 v[216:219], v[4:7], v[196:199], v[216:219]
v_mfma_f32_16x16x32_bf16 v[220:223], v[28:31], v[196:199], v[220:223]
v_mfma_f32_16x16x32_bf16 v[224:227], v[52:55], v[196:199], v[224:227]
v_mfma_f32_16x16x32_bf16 v[216:219], v[8:11], v[200:203], v[216:219]
v_mfma_f32_16x16x32_bf16 v[220:223], v[32:35], v[200:203], v[220:223]
v_mfma_f32_16x16x32_bf16 v[224:227], v[56:59], v[200:203], v[224:227]
v_mfma_f32_16x16x32_bf16 v[216:219], v[12:15], v[204:207], v[216:219]
v_mfma_f32_16x16x32_bf16 v[220:223], v[36:39], v[204:207], v[220:223]
v_add_f32_dpp v249, v249, v249 row_half_mirror row_mask:0xf bank_mask:0xa
v_add_f32_dpp v251, v251, v251 row_half_mirror row_mask:0xf bank_mask:0xa
v_mfma_f32_16x16x32_bf16 v[224:227], v[60:63], v[204:207], v[224:227]
v_add_f32_dpp v249, v248, v248 row_half_mirror row_mask:0xf bank_mask:0x5
v_add_f32_dpp v251, v250, v250 row_half_mirror row_mask:0xf bank_mask:0x5
v_mfma_f32_16x16x32_bf16 v[216:219], v[16:19], v[208:211], v[216:219]
v_add_f32_dpp v249, v249, v249 quad_perm:[1,0,3,2] row_mask:0xf bank_mask:0xf
v_add_f32_dpp v251, v251, v251 quad_perm:[1,0,3,2] row_mask:0xf bank_mask:0xf
v_mfma_f32_16x16x32_bf16 v[220:223], v[40:43], v[208:211], v[220:223]
v_add_f32_dpp v249, v249, v249 quad_perm:[2,3,0,1] row_mask:0xf bank_mask:0xf
v_add_f32_dpp v251, v251, v251 quad_perm:[2,3,0,1] row_mask:0xf bank_mask:0xf
v_mfma_f32_16x16x32_bf16 v[224:227], v[64:67], v[208:211], v[224:227]
v_mul_f32 v172, s34, v251
v_fma_f32 v173, -v172, v172, s35
v_mfma_f32_16x16x32_bf16 v[216:219], v[20:23], v[212:215], v[216:219]
v_cvt_pk_bf16_f32 v174, v172, v172
v_fma_f32 v248, v249, s34, v173
v_mfma_f32_16x16x32_bf16 v[220:223], v[44:47], v[212:215], v[220:223]
v_and_b32 v175, 0xffff0000, v174
v_max_f32 v248, s35, v248
v_mfma_f32_16x16x32_bf16 v[224:227], v[68:71], v[212:215], v[224:227]
v_sub_f32 v172, v172, v175
v_rsq_f32 v248, v248
v_cvt_pk_bf16_f32 v175, v175, v172
PJ23:
s_mov_b64 exec, s[0:1]
ds_write2st64_b32 v245, v175, v174 offset0:1 offset1:2
ds_write_b32 v245, v248
s_mov_b64 exec, -1
v_add_u32 v245, s28, v245
ds_write_b128 v237, v[216:219] offset:0
ds_write_b128 v238, v[220:223] offset:0
ds_write_b128 v239, v[224:227] offset:0
v_add_u32 v237, s36, v237
v_add_u32 v238, s36, v238
v_add_u32 v239, s36, v239
s_setprio 0
ds_read_b128 v[144:147], v240 offset:0
ds_read_b128 v[148:151], v240 offset:6144
ds_read_b128 v[152:155], v240 offset:128
ds_read_b128 v[156:159], v240 offset:6272
ds_read_b128 v[160:163], v240 offset:256
ds_read_b128 v[164:167], v240 offset:6400
v_subrev_u32 v240, s36, v240
ds_read_b128 v[192:195], v235 offset:0
ds_read_b128 v[196:199], v236 offset:0
ds_read_b128 v[200:203], v235 offset:128
ds_read_b128 v[204:207], v236 offset:128
ds_read_b128 v[208:211], v235 offset:256
ds_read_b128 v[212:215], v236 offset:256
s_add_u32 s38, s38, 1
s_and_b32 s38, s38, 3
s_cmp_eq_u32 s38, 0
s_cselect_b32 s30, 0xffffb800, s46
v_add_u32 v235, s30, v235
v_add_u32 v236, s30, v236
s_sub_u32 s36, 0, s36
s_cmp_lt_u32 s27, s18
s_cbranch_scc1 PN_l0
PN_lr0:
s_and_b32 s32, s31, 3
s_mul_i32 s32, s32, 6144
s_add_u32 m0, s32, s33
s_add_u32 s31, s31, 1
s_cmp_le_u32 s31, 16
s_cselect_b32 s14, s14, 0
s_mov_b64 exec, s[42:43]
buffer_load_dwordx4 v246, s[12:15], s29 offen nt lds
buffer_load_dwordx4 v247, s[12:15], s29 offen offset:768 nt lds
s_mov_b64 exec, -1
s_add_u32 s29, s29, 6144
s_waitcnt vmcnt(16) lgkmcnt(12)
s_setprio 3
s_cmp_lt_u32 s27, 13
s_cbranch_scc1 PL_loop
s_barrier
v_mul_u32_u24 v253, 0x20004, v252
v_and_b32 v253, 0x1e0040, v253
s_lshl_b32 s41, s3, 9
s_lshl_b32 s40, s24, 7
s_add_u32 s41, s41, s40
s_add_u32 s41, s41, 786432
buffer_load_dword v253, v253, s[20:23], s41 offen sc1
s_waitcnt lgkmcnt(6)
v_mfma_f32_16x16x16_bf16 v[168:171], v[232:233], v[108:109], v[144:147]
v_mfma_f32_16x16x16_bf16 v[172:175], v[232:233], v[110:111], v[148:151]
v_mfma_f32_16x16x16_bf16 v[176:179], v[232:233], v[112:113], v[152:155]
v_mfma_f32_16x16x16_bf16 v[180:183], v[232:233], v[114:115], v[156:159]
v_mfma_f32_16x16x16_bf16 v[184:187], v[232:233], v[116:117], v[160:163]
v_mfma_f32_16x16x16_bf16 v[188:191], v[232:233], v[118:119], v[164:167]
s_mul_i32 s40, s24, 18432
s_add_u32 s40, s40, 530432
s_nop 0
v_mfma_f32_16x16x16_bf16 v[144:147], v[232:233], v[96:97], v[144:147]
v_cvt_pk_bf16_f32 v168, v168, v169
v_cvt_pk_bf16_f32 v169, v170, v171
v_cvt_pk_bf16_f32 v170, v172, v173
v_cvt_pk_bf16_f32 v171, v174, v175
v_mfma_f32_16x16x16_bf16 v[148:151], v[232:233], v[98:99], v[148:151]
v_cvt_pk_bf16_f32 v176, v176, v177
v_cvt_pk_bf16_f32 v177, v178, v179
v_cvt_pk_bf16_f32 v178, v180, v181
v_cvt_pk_bf16_f32 v179, v182, v183
v_mfma_f32_16x16x16_bf16 v[152:155], v[232:233], v[100:101], v[152:155]
v_cvt_pk_bf16_f32 v184, v184, v185
v_cvt_pk_bf16_f32 v185, v186, v187
v_cvt_pk_bf16_f32 v186, v188, v189
v_cvt_pk_bf16_f32 v187, v190, v191
v_mfma_f32_16x16x16_bf16 v[156:159], v[232:233], v[102:103], v[156:159]
v_mfma_f32_16x16x16_bf16 v[160:163], v[232:233], v[104:105], v[160:163]
v_mfma_f32_16x16x16_bf16 v[164:167], v[232:233], v[106:107], v[164:167]
s_setprio 0
ds_write_b128 v242, v[168:171] offset:0
buffer_load_dwordx4 v[108:111], v234, s[20:23], s40 offen offset:3072 sc1
v_cvt_pk_bf16_f32 v144, v144, v145
v_cvt_pk_bf16_f32 v145, v146, v147
v_cvt_pk_bf16_f32 v146, v148, v149
v_cvt_pk_bf16_f32 v147, v150, v151
ds_write_b128 v242, v[176:179] offset:128
buffer_load_dwordx4 v[112:115], v234, s[20:23], s40 offen offset:3200 sc1
v_cvt_pk_bf16_f32 v152, v152, v153
v_cvt_pk_bf16_f32 v153, v154, v155
v_cvt_pk_bf16_f32 v154, v156, v157
v_cvt_pk_bf16_f32 v155, v158, v159
ds_write_b128 v242, v[184:187] offset:256
buffer_load_dwordx4 v[116:119], v234, s[20:23], s40 offen offset:3328 sc1
v_cvt_pk_bf16_f32 v160, v160, v161
v_cvt_pk_bf16_f32 v161, v162, v163
v_cvt_pk_bf16_f32 v162, v164, v165
v_cvt_pk_bf16_f32 v163, v166, v167
ds_write_b128 v241, v[144:147] offset:0
buffer_load_dwordx4 v[96:99], v234, s[20:23], s40 offen offset:0 sc1
ds_write_b128 v241, v[152:155] offset:128
buffer_load_dwordx4 v[100:103], v234, s[20:23], s40 offen offset:128 sc1
ds_write_b128 v241, v[160:163] offset:256
buffer_load_dwordx4 v[104:107], v234, s[20:23], s40 offen offset:256 sc1
s_setprio 0
s_add_u32 s27, s27, 1
s_and_b32 s28, s27, 3
s_cmp_eq_u32 s28, 0
s_cselect_b32 s28, 0xfffed700, s47
v_add_u32 v241, s28, v241
v_add_u32 v242, s28, v242
v_dot2_f32_bf16 v249, v168, v168, 0
v_dot2_f32_bf16 v251, v168, v228, 0
v_dot2_f32_bf16 v249, v169, v169, v249
v_dot2_f32_bf16 v251, v169, v228, v251
v_dot2_f32_bf16 v249, v170, v170, v249
v_dot2_f32_bf16 v251, v170, v228, v251
v_dot2_f32_bf16 v249, v171, v171, v249
v_dot2_f32_bf16 v251, v171, v228, v251
v_dot2_f32_bf16 v249, v176, v176, v249
v_dot2_f32_bf16 v251, v176, v228, v251
v_dot2_f32_bf16 v249, v177, v177, v249
v_dot2_f32_bf16 v251, v177, v228, v251
v_dot2_f32_bf16 v249, v178, v178, v249
v_dot2_f32_bf16 v251, v178, v228, v251
v_dot2_f32_bf16 v249, v179, v179, v249
v_dot2_f32_bf16 v251, v179, v228, v251
v_dot2_f32_bf16 v249, v184, v184, v249
v_dot2_f32_bf16 v251, v184, v228, v251
v_dot2_f32_bf16 v249, v185, v185, v249
v_dot2_f32_bf16 v251, v185, v228, v251
v_dot2_f32_bf16 v249, v186, v186, v249
v_dot2_f32_bf16 v251, v186, v228, v251
v_dot2_f32_bf16 v249, v187, v187, v249
v_dot2_f32_bf16 v251, v187, v228, v251
v_dot2_f32_bf16 v248, v144, v144, 0
v_dot2_f32_bf16 v250, v144, v228, 0
v_dot2_f32_bf16 v248, v145, v145, v248
v_dot2_f32_bf16 v250, v145, v228, v250
v_dot2_f32_bf16 v248, v146, v146, v248
v_dot2_f32_bf16 v250, v146, v228, v250
v_dot2_f32_bf16 v248, v147, v147, v248
v_dot2_f32_bf16 v250, v147, v228, v250
v_dot2_f32_bf16 v248, v152, v152, v248
v_dot2_f32_bf16 v250, v152, v228, v250
v_dot2_f32_bf16 v248, v153, v153, v248
v_dot2_f32_bf16 v250, v153, v228, v250
v_dot2_f32_bf16 v248, v154, v154, v248
v_dot2_f32_bf16 v250, v154, v228, v250
v_dot2_f32_bf16 v248, v155, v155, v248
v_dot2_f32_bf16 v250, v155, v228, v250
v_dot2_f32_bf16 v248, v160, v160, v248
v_dot2_f32_bf16 v250, v160, v228, v250
v_dot2_f32_bf16 v248, v161, v161, v248
v_dot2_f32_bf16 v250, v161, v228, v250
v_dot2_f32_bf16 v248, v162, v162, v248
v_dot2_f32_bf16 v250, v162, v228, v250
v_dot2_f32_bf16 v248, v163, v163, v248
v_dot2_f32_bf16 v250, v163, v228, v250
s_setprio 3
s_waitcnt lgkmcnt(6)
v_mfma_f32_16x16x32_bf16 v[216:219], v[0:3], v[192:195], 0
v_mfma_f32_16x16x32_bf16 v[220:223], v[24:27], v[192:195], 0
v_mfma_f32_16x16x32_bf16 v[224:227], v[48:51], v[192:195], 0
v_mfma_f32_16x16x32_bf16 v[216:219], v[4:7], v[196:199], v[216:219]
v_mfma_f32_16x16x32_bf16 v[220:223], v[28:31], v[196:199], v[220:223]
v_mfma_f32_16x16x32_bf16 v[224:227], v[52:55], v[196:199], v[224:227]
v_mfma_f32_16x16x32_bf16 v[216:219], v[8:11], v[200:203], v[216:219]
v_mfma_f32_16x16x32_bf16 v[220:223], v[32:35], v[200:203], v[220:223]
v_mfma_f32_16x16x32_bf16 v[224:227], v[56:59], v[200:203], v[224:227]
v_mfma_f32_16x16x32_bf16 v[216:219], v[12:15], v[204:207], v[216:219]
v_mfma_f32_16x16x32_bf16 v[220:223], v[36:39], v[204:207], v[220:223]
v_add_f32_dpp v249, v249, v249 row_half_mirror row_mask:0xf bank_mask:0xa
v_add_f32_dpp v251, v251, v251 row_half_mirror row_mask:0xf bank_mask:0xa
v_mfma_f32_16x16x32_bf16 v[224:227], v[60:63], v[204:207], v[224:227]
v_add_f32_dpp v249, v248, v248 row_half_mirror row_mask:0xf bank_mask:0x5
v_add_f32_dpp v251, v250, v250 row_half_mirror row_mask:0xf bank_mask:0x5
v_mfma_f32_16x16x32_bf16 v[216:219], v[16:19], v[208:211], v[216:219]
v_add_f32_dpp v249, v249, v249 quad_perm:[1,0,3,2] row_mask:0xf bank_mask:0xf
v_add_f32_dpp v251, v251, v251 quad_perm:[1,0,3,2] row_mask:0xf bank_mask:0xf
v_mfma_f32_16x16x32_bf16 v[220:223], v[40:43], v[208:211], v[220:223]
v_add_f32_dpp v249, v249, v249 quad_perm:[2,3,0,1] row_mask:0xf bank_mask:0xf
v_add_f32_dpp v251, v251, v251 quad_perm:[2,3,0,1] row_mask:0xf bank_mask:0xf
v_mfma_f32_16x16x32_bf16 v[224:227], v[64:67], v[208:211], v[224:227]
v_mul_f32 v172, s34, v251
v_fma_f32 v173, -v172, v172, s35
v_mfma_f32_16x16x32_bf16 v[216:219], v[20:23], v[212:215], v[216:219]
v_cvt_pk_bf16_f32 v174, v172, v172
v_fma_f32 v248, v249, s34, v173
v_mfma_f32_16x16x32_bf16 v[220:223], v[44:47], v[212:215], v[220:223]
v_and_b32 v175, 0xffff0000, v174
v_max_f32 v248, s35, v248
v_mfma_f32_16x16x32_bf16 v[224:227], v[68:71], v[212:215], v[224:227]
v_sub_f32 v172, v172, v175
v_rsq_f32 v248, v248
v_cvt_pk_bf16_f32 v175, v175, v172
s_mov_b64 exec, s[0:1]
ds_write2st64_b32 v245, v175, v174 offset0:1 offset1:2
ds_write_b32 v245, v248
s_mov_b64 exec, -1
v_add_u32 v245, s28, v245
ds_write_b128 v237, v[216:219] offset:0
ds_write_b128 v238, v[220:223] offset:0
ds_write_b128 v239, v[224:227] offset:0
v_add_u32 v237, s36, v237
v_add_u32 v238, s36, v238
v_add_u32 v239, s36, v239
s_setprio 0
ds_read_b128 v[144:147], v240 offset:0
ds_read_b128 v[148:151], v240 offset:6144
ds_read_b128 v[152:155], v240 offset:128
ds_read_b128 v[156:159], v240 offset:6272
ds_read_b128 v[160:163], v240 offset:256
ds_read_b128 v[164:167], v240 offset:6400
v_subrev_u32 v240, s36, v240
s_sub_u32 s36, 0, s36
s_waitcnt vmcnt(14) lgkmcnt(6)
s_setprio 3
s_barrier
s_waitcnt lgkmcnt(0)
v_mfma_f32_16x16x16_bf16 v[168:171], v[232:233], v[132:133], v[144:147]
v_mfma_f32_16x16x16_bf16 v[172:175], v[232:233], v[134:135], v[148:151]
v_mfma_f32_16x16x16_bf16 v[176:179], v[232:233], v[136:137], v[152:155]
v_mfma_f32_16x16x16_bf16 v[180:183], v[232:233], v[138:139], v[156:159]
v_mfma_f32_16x16x16_bf16 v[184:187], v[232:233], v[140:141], v[160:163]
v_mfma_f32_16x16x16_bf16 v[188:191], v[232:233], v[142:143], v[164:167]
s_mul_i32 s40, s24, 18432
s_add_u32 s40, s40, 536576
s_nop 0
v_mfma_f32_16x16x16_bf16 v[144:147], v[232:233], v[120:121], v[144:147]
v_cvt_pk_bf16_f32 v168, v168, v169
v_cvt_pk_bf16_f32 v169, v170, v171
v_cvt_pk_bf16_f32 v170, v172, v173
v_cvt_pk_bf16_f32 v171, v174, v175
v_mfma_f32_16x16x16_bf16 v[148:151], v[232:233], v[122:123], v[148:151]
v_cvt_pk_bf16_f32 v176, v176, v177
v_cvt_pk_bf16_f32 v177, v178, v179
v_cvt_pk_bf16_f32 v178, v180, v181
v_cvt_pk_bf16_f32 v179, v182, v183
v_mfma_f32_16x16x16_bf16 v[152:155], v[232:233], v[124:125], v[152:155]
v_cvt_pk_bf16_f32 v184, v184, v185
v_cvt_pk_bf16_f32 v185, v186, v187
v_cvt_pk_bf16_f32 v186, v188, v189
v_cvt_pk_bf16_f32 v187, v190, v191
v_mfma_f32_16x16x16_bf16 v[156:159], v[232:233], v[126:127], v[156:159]
v_mfma_f32_16x16x16_bf16 v[160:163], v[232:233], v[128:129], v[160:163]
v_mfma_f32_16x16x16_bf16 v[164:167], v[232:233], v[130:131], v[164:167]
s_setprio 0
ds_write_b128 v242, v[168:171] offset:0
buffer_load_dwordx4 v[132:135], v234, s[20:23], s40 offen offset:3072 sc1
v_cvt_pk_bf16_f32 v144, v144, v145
v_cvt_pk_bf16_f32 v145, v146, v147
v_cvt_pk_bf16_f32 v146, v148, v149
v_cvt_pk_bf16_f32 v147, v150, v151
ds_write_b128 v242, v[176:179] offset:128
buffer_load_dwordx4 v[136:139], v234, s[20:23], s40 offen offset:3200 sc1
v_cvt_pk_bf16_f32 v152, v152, v153
v_cvt_pk_bf16_f32 v153, v154, v155
v_cvt_pk_bf16_f32 v154, v156, v157
v_cvt_pk_bf16_f32 v155, v158, v159
ds_write_b128 v242, v[184:187] offset:256
buffer_load_dwordx4 v[140:143], v234, s[20:23], s40 offen offset:3328 sc1
v_cvt_pk_bf16_f32 v160, v160, v161
v_cvt_pk_bf16_f32 v161, v162, v163
v_cvt_pk_bf16_f32 v162, v164, v165
v_cvt_pk_bf16_f32 v163, v166, v167
ds_write_b128 v241, v[144:147] offset:0
buffer_load_dwordx4 v[120:123], v234, s[20:23], s40 offen offset:0 sc1
ds_write_b128 v241, v[152:155] offset:128
buffer_load_dwordx4 v[124:127], v234, s[20:23], s40 offen offset:128 sc1
ds_write_b128 v241, v[160:163] offset:256
buffer_load_dwordx4 v[128:131], v234, s[20:23], s40 offen offset:256 sc1
s_setprio 0
s_add_u32 s27, s27, 1
s_and_b32 s28, s27, 3
s_cmp_eq_u32 s28, 0
s_cselect_b32 s28, 0xfffed700, s47
v_add_u32 v241, s28, v241
v_add_u32 v242, s28, v242
v_dot2_f32_bf16 v249, v168, v168, 0
v_dot2_f32_bf16 v251, v168, v228, 0
v_dot2_f32_bf16 v249, v169, v169, v249
v_dot2_f32_bf16 v251, v169, v228, v251
v_dot2_f32_bf16 v249, v170, v170, v249
v_dot2_f32_bf16 v251, v170, v228, v251
v_dot2_f32_bf16 v249, v171, v171, v249
v_dot2_f32_bf16 v251, v171, v228, v251
v_dot2_f32_bf16 v249, v176, v176, v249
v_dot2_f32_bf16 v251, v176, v228, v251
v_dot2_f32_bf16 v249, v177, v177, v249
v_dot2_f32_bf16 v251, v177, v228, v251
v_dot2_f32_bf16 v249, v178, v178, v249
v_dot2_f32_bf16 v251, v178, v228, v251
v_dot2_f32_bf16 v249, v179, v179, v249
v_dot2_f32_bf16 v251, v179, v228, v251
v_dot2_f32_bf16 v249, v184, v184, v249
v_dot2_f32_bf16 v251, v184, v228, v251
v_dot2_f32_bf16 v249, v185, v185, v249
v_dot2_f32_bf16 v251, v185, v228, v251
v_dot2_f32_bf16 v249, v186, v186, v249
v_dot2_f32_bf16 v251, v186, v228, v251
v_dot2_f32_bf16 v249, v187, v187, v249
v_dot2_f32_bf16 v251, v187, v228, v251
v_dot2_f32_bf16 v248, v144, v144, 0
v_dot2_f32_bf16 v250, v144, v228, 0
v_dot2_f32_bf16 v248, v145, v145, v248
v_dot2_f32_bf16 v250, v145, v228, v250
v_dot2_f32_bf16 v248, v146, v146, v248
v_dot2_f32_bf16 v250, v146, v228, v250
v_dot2_f32_bf16 v248, v147, v147, v248
v_dot2_f32_bf16 v250, v147, v228, v250
v_dot2_f32_bf16 v248, v152, v152, v248
v_dot2_f32_bf16 v250, v152, v228, v250
v_dot2_f32_bf16 v248, v153, v153, v248
v_dot2_f32_bf16 v250, v153, v228, v250
v_dot2_f32_bf16 v248, v154, v154, v248
v_dot2_f32_bf16 v250, v154, v228, v250
v_dot2_f32_bf16 v248, v155, v155, v248
v_dot2_f32_bf16 v250, v155, v228, v250
v_dot2_f32_bf16 v248, v160, v160, v248
v_dot2_f32_bf16 v250, v160, v228, v250
v_dot2_f32_bf16 v248, v161, v161, v248
v_dot2_f32_bf16 v250, v161, v228, v250
v_dot2_f32_bf16 v248, v162, v162, v248
v_dot2_f32_bf16 v250, v162, v228, v250
v_dot2_f32_bf16 v248, v163, v163, v248
v_dot2_f32_bf16 v250, v163, v228, v250
s_setprio 3
s_nop 1
v_add_f32_dpp v249, v249, v249 row_half_mirror row_mask:0xf bank_mask:0xa
v_add_f32_dpp v251, v251, v251 row_half_mirror row_mask:0xf bank_mask:0xa
v_add_f32_dpp v249, v248, v248 row_half_mirror row_mask:0xf bank_mask:0x5
v_add_f32_dpp v251, v250, v250 row_half_mirror row_mask:0xf bank_mask:0x5
s_nop 0
v_add_f32_dpp v249, v249, v249 quad_perm:[1,0,3,2] row_mask:0xf bank_mask:0xf
v_add_f32_dpp v251, v251, v251 quad_perm:[1,0,3,2] row_mask:0xf bank_mask:0xf
s_nop 0
v_add_f32_dpp v249, v249, v249 quad_perm:[2,3,0,1] row_mask:0xf bank_mask:0xf
v_add_f32_dpp v251, v251, v251 quad_perm:[2,3,0,1] row_mask:0xf bank_mask:0xf
v_mul_f32 v172, s34, v251
v_fma_f32 v173, -v172, v172, s35
v_cvt_pk_bf16_f32 v174, v172, v172
v_fma_f32 v248, v249, s34, v173
v_and_b32 v175, 0xffff0000, v174
v_max_f32 v248, s35, v248
v_sub_f32 v172, v172, v175
v_rsq_f32 v248, v248
v_cvt_pk_bf16_f32 v175, v175, v172
s_mov_b64 exec, s[0:1]
ds_write2st64_b32 v245, v175, v174 offset0:1 offset1:2
ds_write_b32 v245, v248
s_mov_b64 exec, -1
v_add_u32 v245, s28, v245
s_setprio 0
ds_read_b128 v[144:147], v240 offset:0
ds_read_b128 v[148:151], v240 offset:6144
ds_read_b128 v[152:155], v240 offset:128
ds_read_b128 v[156:159], v240 offset:6272
ds_read_b128 v[160:163], v240 offset:256
ds_read_b128 v[164:167], v240 offset:6400
v_subrev_u32 v240, s36, v240
s_sub_u32 s36, 0, s36
s_waitcnt vmcnt(12) lgkmcnt(6)
s_setprio 3
s_barrier
s_waitcnt lgkmcnt(0)
v_mfma_f32_16x16x16_bf16 v[168:171], v[232:233], v[84:85], v[144:147]
v_mfma_f32_16x16x16_bf16 v[172:175], v[232:233], v[86:87], v[148:151]
v_mfma_f32_16x16x16_bf16 v[176:179], v[232:233], v[88:89], v[152:155]
v_mfma_f32_16x16x16_bf16 v[180:183], v[232:233], v[90:91], v[156:159]
v_mfma_f32_16x16x16_bf16 v[184:187], v[232:233], v[92:93], v[160:163]
v_mfma_f32_16x16x16_bf16 v[188:191], v[232:233], v[94:95], v[164:167]
s_mul_i32 s40, s24, 18432
s_add_u32 s40, s40, 524288
s_nop 0
v_mfma_f32_16x16x16_bf16 v[144:147], v[232:233], v[72:73], v[144:147]
v_cvt_pk_bf16_f32 v168, v168, v169
v_cvt_pk_bf16_f32 v169, v170, v171
v_cvt_pk_bf16_f32 v170, v172, v173
v_cvt_pk_bf16_f32 v171, v174, v175
v_mfma_f32_16x16x16_bf16 v[148:151], v[232:233], v[74:75], v[148:151]
v_cvt_pk_bf16_f32 v176, v176, v177
v_cvt_pk_bf16_f32 v177, v178, v179
v_cvt_pk_bf16_f32 v178, v180, v181
v_cvt_pk_bf16_f32 v179, v182, v183
v_mfma_f32_16x16x16_bf16 v[152:155], v[232:233], v[76:77], v[152:155]
v_cvt_pk_bf16_f32 v184, v184, v185
v_cvt_pk_bf16_f32 v185, v186, v187
v_cvt_pk_bf16_f32 v186, v188, v189
v_cvt_pk_bf16_f32 v187, v190, v191
v_mfma_f32_16x16x16_bf16 v[156:159], v[232:233], v[78:79], v[156:159]
v_mfma_f32_16x16x16_bf16 v[160:163], v[232:233], v[80:81], v[160:163]
v_mfma_f32_16x16x16_bf16 v[164:167], v[232:233], v[82:83], v[164:167]
s_setprio 0
ds_write_b128 v242, v[168:171] offset:0
buffer_load_dwordx4 v[84:87], v234, s[20:23], s40 offen offset:3072 sc1
v_cvt_pk_bf16_f32 v144, v144, v145
v_cvt_pk_bf16_f32 v145, v146, v147
v_cvt_pk_bf16_f32 v146, v148, v149
v_cvt_pk_bf16_f32 v147, v150, v151
ds_write_b128 v242, v[176:179] offset:128
buffer_load_dwordx4 v[88:91], v234, s[20:23], s40 offen offset:3200 sc1
v_cvt_pk_bf16_f32 v152, v152, v153
v_cvt_pk_bf16_f32 v153, v154, v155
v_cvt_pk_bf16_f32 v154, v156, v157
v_cvt_pk_bf16_f32 v155, v158, v159
ds_write_b128 v242, v[184:187] offset:256
buffer_load_dwordx4 v[92:95], v234, s[20:23], s40 offen offset:3328 sc1
v_cvt_pk_bf16_f32 v160, v160, v161
v_cvt_pk_bf16_f32 v161, v162, v163
v_cvt_pk_bf16_f32 v162, v164, v165
v_cvt_pk_bf16_f32 v163, v166, v167
ds_write_b128 v241, v[144:147] offset:0
buffer_load_dwordx4 v[72:75], v234, s[20:23], s40 offen offset:0 sc1
ds_write_b128 v241, v[152:155] offset:128
buffer_load_dwordx4 v[76:79], v234, s[20:23], s40 offen offset:128 sc1
ds_write_b128 v241, v[160:163] offset:256
buffer_load_dwordx4 v[80:83], v234, s[20:23], s40 offen offset:256 sc1
s_setprio 0
v_dot2_f32_bf16 v249, v168, v168, 0
v_dot2_f32_bf16 v251, v168, v228, 0
v_dot2_f32_bf16 v249, v169, v169, v249
v_dot2_f32_bf16 v251, v169, v228, v251
v_dot2_f32_bf16 v249, v170, v170, v249
v_dot2_f32_bf16 v251, v170, v228, v251
v_dot2_f32_bf16 v249, v171, v171, v249
v_dot2_f32_bf16 v251, v171, v228, v251
v_dot2_f32_bf16 v249, v176, v176, v249
v_dot2_f32_bf16 v251, v176, v228, v251
v_dot2_f32_bf16 v249, v177, v177, v249
v_dot2_f32_bf16 v251, v177, v228, v251
v_dot2_f32_bf16 v249, v178, v178, v249
v_dot2_f32_bf16 v251, v178, v228, v251
v_dot2_f32_bf16 v249, v179, v179, v249
v_dot2_f32_bf16 v251, v179, v228, v251
v_dot2_f32_bf16 v249, v184, v184, v249
v_dot2_f32_bf16 v251, v184, v228, v251
v_dot2_f32_bf16 v249, v185, v185, v249
v_dot2_f32_bf16 v251, v185, v228, v251
v_dot2_f32_bf16 v249, v186, v186, v249
v_dot2_f32_bf16 v251, v186, v228, v251
v_dot2_f32_bf16 v249, v187, v187, v249
v_dot2_f32_bf16 v251, v187, v228, v251
v_dot2_f32_bf16 v248, v144, v144, 0
v_dot2_f32_bf16 v250, v144, v228, 0
v_dot2_f32_bf16 v248, v145, v145, v248
v_dot2_f32_bf16 v250, v145, v228, v250
v_dot2_f32_bf16 v248, v146, v146, v248
v_dot2_f32_bf16 v250, v146, v228, v250
v_dot2_f32_bf16 v248, v147, v147, v248
v_dot2_f32_bf16 v250, v147, v228, v250
v_dot2_f32_bf16 v248, v152, v152, v248
v_dot2_f32_bf16 v250, v152, v228, v250
v_dot2_f32_bf16 v248, v153, v153, v248
v_dot2_f32_bf16 v250, v153, v228, v250
v_dot2_f32_bf16 v248, v154, v154, v248
v_dot2_f32_bf16 v250, v154, v228, v250
v_dot2_f32_bf16 v248, v155, v155, v248
v_dot2_f32_bf16 v250, v155, v228, v250
v_dot2_f32_bf16 v248, v160, v160, v248
v_dot2_f32_bf16 v250, v160, v228, v250
v_dot2_f32_bf16 v248, v161, v161, v248
v_dot2_f32_bf16 v250, v161, v228, v250
v_dot2_f32_bf16 v248, v162, v162, v248
v_dot2_f32_bf16 v250, v162, v228, v250
v_dot2_f32_bf16 v248, v163, v163, v248
v_dot2_f32_bf16 v250, v163, v228, v250
s_setprio 3
s_nop 1
v_add_f32_dpp v249, v249, v249 row_half_mirror row_mask:0xf bank_mask:0xa
v_add_f32_dpp v251, v251, v251 row_half_mirror row_mask:0xf bank_mask:0xa
v_add_f32_dpp v249, v248, v248 row_half_mirror row_mask:0xf bank_mask:0x5
v_add_f32_dpp v251, v250, v250 row_half_mirror row_mask:0xf bank_mask:0x5
s_nop 0
v_add_f32_dpp v249, v249, v249 quad_perm:[1,0,3,2] row_mask:0xf bank_mask:0xf
v_add_f32_dpp v251, v251, v251 quad_perm:[1,0,3,2] row_mask:0xf bank_mask:0xf
s_nop 0
v_add_f32_dpp v249, v249, v249 quad_perm:[2,3,0,1] row_mask:0xf bank_mask:0xf
v_add_f32_dpp v251, v251, v251 quad_perm:[2,3,0,1] row_mask:0xf bank_mask:0xf
v_mul_f32 v172, s34, v251
v_fma_f32 v173, -v172, v172, s35
v_cvt_pk_bf16_f32 v174, v172, v172
v_fma_f32 v248, v249, s34, v173
v_and_b32 v175, 0xffff0000, v174
v_max_f32 v248, s35, v248
v_sub_f32 v172, v172, v175
v_rsq_f32 v248, v248
v_cvt_pk_bf16_f32 v175, v175, v172
s_mov_b64 exec, s[0:1]
ds_write2st64_b32 v245, v175, v174 offset0:1 offset1:2
ds_write_b32 v245, v248
s_mov_b64 exec, -1
s_setprio 0
s_waitcnt lgkmcnt(0)
s_barrier
s_cmp_lt_i32 s5, 0
s_cbranch_scc1 PE_nowo
s_mul_i32 s8, s24, 18432
s_add_u32 s8, s8, 598016
buffer_load_dwordx4 v[144:147], v234, s[20:23], s8 offen offset:0 sc1
buffer_load_dwordx4 v[148:151], v234, s[20:23], s8 offen offset:128 sc1
buffer_load_dwordx4 v[152:155], v234, s[20:23], s8 offen offset:256 sc1
buffer_load_dwordx4 v[156:159], v234, s[20:23], s8 offen offset:3072 sc1
buffer_load_dwordx4 v[160:163], v234, s[20:23], s8 offen offset:3200 sc1
buffer_load_dwordx4 v[164:167], v234, s[20:23], s8 offen offset:3328 sc1
s_add_u32 s8, s8, 6144
buffer_load_dwordx4 v[168:171], v234, s[20:23], s8 offen offset:0 sc1
buffer_load_dwordx4 v[172:175], v234, s[20:23], s8 offen offset:128 sc1
buffer_load_dwordx4 v[176:179], v234, s[20:23], s8 offen offset:256 sc1
buffer_load_dwordx4 v[180:183], v234, s[20:23], s8 offen offset:3072 sc1
buffer_load_dwordx4 v[184:187], v234, s[20:23], s8 offen offset:3200 sc1
buffer_load_dwordx4 v[188:191], v234, s[20:23], s8 offen offset:3328 sc1
s_add_u32 s8, s8, 6144
buffer_load_dwordx4 v[192:195], v234, s[20:23], s8 offen offset:0 sc1
buffer_load_dwordx4 v[196:199], v234, s[20:23], s8 offen offset:128 sc1
buffer_load_dwordx4 v[200:203], v234, s[20:23], s8 offen offset:256 sc1
buffer_load_dwordx4 v[204:207], v234, s[20:23], s8 offen offset:3072 sc1
buffer_load_dwordx4 v[208:211], v234, s[20:23], s8 offen offset:3200 sc1
buffer_load_dwordx4 v[212:215], v234, s[20:23], s8 offen offset:3328 sc1
s_mov_b32 s28, s48
s_mov_b32 s29, s49
s_mov_b32 s30, 6144
s_mov_b32 s31, 0x20000
s_mov_b32 s16, s66
s_mov_b32 s17, s67
s_mov_b32 s18, 6144
s_mov_b32 s19, 0x20000
v_lshrrev_b32 v247, 4, v252
v_lshlrev_b32 v247, 3, v247
s_mul_i32 s8, s5, 384
s_mul_i32 s9, s24, 96
s_add_u32 s8, s8, s9
buffer_load_dwordx2 v[240:241], v247, s[28:31], s8 offen offset:0
buffer_load_dwordx2 v[242:243], v247, s[28:31], s8 offen offset:32
buffer_load_dwordx2 v[244:245], v247, s[28:31], s8 offen offset:64
PE_nowo:
v_and_b32 v248, 15, v252
v_lshrrev_b32 v251, 4, v252
s_mul_i32 s37, s24, 6144
s_add_u32 s37, s37, 101376
v_lshl_add_u32 v250, v252, 4, s37
s_lshl_b32 s37, s24, 9
s_add_u32 s37, s37, 150528
v_lshl_add_u32 v249, v248, 5, s37
v_mul_u32_u24 v246, 0x20002, v248
v_and_b32 v246, 0xe0010, v246
v_lshl_add_u32 v246, v251, 5, v246
s_lshl_b32 s42, s3, 9
s_lshl_b32 s37, s24, 7
s_add_u32 s42, s42, s37
s_add_u32 s42, s42, 786432
s_waitcnt vmcnt(21)
s_cmp_lt_i32 s5, 0
s_cbranch_scc0 PE_w
s_waitcnt vmcnt(0)
PE_w:
s_barrier
ds_read_b128 v[48:51], v249
ds_read_b128 v[52:55], v249 offset:16
ds_read_b128 v[0:3], v250 offset:0
ds_read_b128 v[24:27], v250 offset:24576
ds_read_b128 v[4:7], v250 offset:1024
ds_read_b128 v[28:31], v250 offset:25600
ds_read_b128 v[8:11], v250 offset:2048
ds_read_b128 v[32:35], v250 offset:26624
ds_read_b128 v[12:15], v250 offset:3072
ds_read_b128 v[36:39], v250 offset:27648
ds_read_b128 v[16:19], v250 offset:4096
ds_read_b128 v[40:43], v250 offset:28672
ds_read_b128 v[20:23], v250 offset:5120
ds_read_b128 v[44:47], v250 offset:29696
s_waitcnt lgkmcnt(10)
v_mfma_f32_16x16x32_bf16 v[216:219], v[72:75], v[0:3], 0
v_max_f32 v59, v48, v52
v_mfma_f32_16x16x32_bf16 v[220:223], v[96:99], v[0:3], 0
v_sub_f32 v56, v48, v59
v_mfma_f32_16x16x32_bf16 v[224:227], v[120:123], v[0:3], 0
v_sub_f32 v57, v52, v59
v_mfma_f32_16x16x32_bf16 v[228:231], v[72:75], v[24:27], 0
v_exp_f32 v56, v56
v_mfma_f32_16x16x32_bf16 v[232:235], v[96:99], v[24:27], 0
v_exp_f32 v57, v57
v_mfma_f32_16x16x32_bf16 v[236:239], v[120:123], v[24:27], 0
v_add_f32 v49, v49, v51
s_waitcnt lgkmcnt(8)
v_mfma_f32_16x16x32_bf16 v[216:219], v[76:79], v[4:7], v[216:219]
v_add_f32 v53, v53, v55
v_mfma_f32_16x16x32_bf16 v[220:223], v[100:103], v[4:7], v[220:223]
v_mul_f32 v60, v56, v49
v_mfma_f32_16x16x32_bf16 v[224:227], v[124:127], v[4:7], v[224:227]
v_fma_f32 v60, v57, v53, v60
v_mfma_f32_16x16x32_bf16 v[228:231], v[76:79], v[28:31], v[228:231]
v_rcp_f32 v58, v60
v_mfma_f32_16x16x32_bf16 v[232:235], v[100:103], v[28:31], v[232:235]
v_log_f32 v60, v60
v_mfma_f32_16x16x32_bf16 v[236:239], v[124:127], v[28:31], v[236:239]
v_mul_f32 v56, v56, v58
s_waitcnt lgkmcnt(6)
v_mfma_f32_16x16x32_bf16 v[216:219], v[80:83], v[8:11], v[216:219]
v_mul_f32 v57, v57, v58
v_mfma_f32_16x16x32_bf16 v[220:223], v[104:107], v[8:11], v[220:223]
v_add_f32 v67, v59, v60
v_mfma_f32_16x16x32_bf16 v[224:227], v[128:131], v[8:11], v[224:227]
v_add_u32 v71, s7, v67
v_mfma_f32_16x16x32_bf16 v[228:231], v[80:83], v[32:35], v[228:231]
v_mfma_f32_16x16x32_bf16 v[232:235], v[104:107], v[32:35], v[232:235]
v_mfma_f32_16x16x32_bf16 v[236:239], v[128:131], v[32:35], v[236:239]
s_waitcnt lgkmcnt(4)
v_mfma_f32_16x16x32_bf16 v[216:219], v[84:87], v[12:15], v[216:219]
v_mfma_f32_16x16x32_bf16 v[220:223], v[108:111], v[12:15], v[220:223]
v_mfma_f32_16x16x32_bf16 v[224:227], v[132:135], v[12:15], v[224:227]
v_mfma_f32_16x16x32_bf16 v[228:231], v[84:87], v[36:39], v[228:231]
v_mfma_f32_16x16x32_bf16 v[232:235], v[108:111], v[36:39], v[232:235]
v_mfma_f32_16x16x32_bf16 v[236:239], v[132:135], v[36:39], v[236:239]
s_waitcnt lgkmcnt(2)
v_mfma_f32_16x16x32_bf16 v[216:219], v[88:91], v[16:19], v[216:219]
v_mfma_f32_16x16x32_bf16 v[220:223], v[112:115], v[16:19], v[220:223]
v_mfma_f32_16x16x32_bf16 v[224:227], v[136:139], v[16:19], v[224:227]
v_mfma_f32_16x16x32_bf16 v[228:231], v[88:91], v[40:43], v[228:231]
v_mfma_f32_16x16x32_bf16 v[232:235], v[112:115], v[40:43], v[232:235]
v_mfma_f32_16x16x32_bf16 v[236:239], v[136:139], v[40:43], v[236:239]
s_waitcnt lgkmcnt(0)
v_mfma_f32_16x16x32_bf16 v[216:219], v[92:95], v[20:23], v[216:219]
v_mfma_f32_16x16x32_bf16 v[220:223], v[116:119], v[20:23], v[220:223]
v_mfma_f32_16x16x32_bf16 v[224:227], v[140:143], v[20:23], v[224:227]
v_mfma_f32_16x16x32_bf16 v[228:231], v[92:95], v[44:47], v[228:231]
v_mfma_f32_16x16x32_bf16 v[232:235], v[116:119], v[44:47], v[232:235]
v_mfma_f32_16x16x32_bf16 v[236:239], v[140:143], v[44:47], v[236:239]
s_nop 4
v_pk_mul_f32 v[216:217], v[216:217], v[56:57] op_sel_hi:[1,0]
v_pk_mul_f32 v[218:219], v[218:219], v[56:57] op_sel_hi:[1,0]
v_pk_mul_f32 v[220:221], v[220:221], v[56:57] op_sel_hi:[1,0]
v_pk_mul_f32 v[222:223], v[222:223], v[56:57] op_sel_hi:[1,0]
v_pk_mul_f32 v[224:225], v[224:225], v[56:57] op_sel_hi:[1,0]
v_pk_mul_f32 v[226:227], v[226:227], v[56:57] op_sel_hi:[1,0]
v_pk_fma_f32 v[216:217], v[228:229], v[56:57], v[216:217] op_sel:[0,1,0] op_sel_hi:[1,1,1]
v_pk_fma_f32 v[218:219], v[230:231], v[56:57], v[218:219] op_sel:[0,1,0] op_sel_hi:[1,1,1]
v_pk_fma_f32 v[220:221], v[232:233], v[56:57], v[220:221] op_sel:[0,1,0] op_sel_hi:[1,1,1]
v_pk_fma_f32 v[222:223], v[234:235], v[56:57], v[222:223] op_sel:[0,1,0] op_sel_hi:[1,1,1]
v_pk_fma_f32 v[224:225], v[236:237], v[56:57], v[224:225] op_sel:[0,1,0] op_sel_hi:[1,1,1]
v_pk_fma_f32 v[226:227], v[238:239], v[56:57], v[226:227] op_sel:[0,1,0] op_sel_hi:[1,1,1]
v_cvt_pk_bf16_f32 v64, v216, v217
v_cvt_pk_bf16_f32 v65, v218, v219
v_cvt_pk_bf16_f32 v66, v220, v221
v_cvt_pk_bf16_f32 v68, v222, v223
v_mov_b32 v48, v64
v_mov_b32 v49, v65
v_mov_b32 v50, v66
v_mov_b32 v51, v67
v_cvt_pk_bf16_f32 v69, v224, v225
v_cvt_pk_bf16_f32 v70, v226, v227
s_add_u32 s37, s42, 0x100000
v_mov_b32_dpp v67, v71 row_ror:8 row_mask:0xf bank_mask:0xc
v_mov_b32_dpp v64, v68 row_ror:8 row_mask:0xf bank_mask:0xc
v_mov_b32_dpp v65, v69 row_ror:8 row_mask:0xf bank_mask:0xc
v_mov_b32_dpp v66, v70 row_ror:8 row_mask:0xf bank_mask:0xc
v_mov_b32_dpp v68, v48 row_ror:8 row_mask:0xf bank_mask:0x3
v_mov_b32_dpp v69, v49 row_ror:8 row_mask:0xf bank_mask:0x3
v_mov_b32_dpp v70, v50 row_ror:8 row_mask:0xf bank_mask:0x3
v_mov_b32_dpp v71, v51 row_ror:8 row_mask:0xf bank_mask:0x3
buffer_store_dwordx4 v[64:67], v246, s[20:23], s42 offen sc1
buffer_store_dwordx4 v[68:71], v246, s[20:23], s37 offen sc1
v_mov_b32 v0, v252
s_cmp_lt_i32 s5, 0
s_cbranch_scc0 FIN
s_endpgm
PN_sync:
v_lshlrev_b32 v248, 2, v252
v_and_b32 v248, 31, v248
v_add_u32 v248, 158720, v248
FW24:
ds_read_b32 v249, v248
s_waitcnt lgkmcnt(0)
v_cmp_eq_u32 vcc, 1, v249
s_and_b32 s6, vcc_lo, 15
s_cmp_eq_u32 s6, 15
s_cbranch_scc0 FW24
s_branch PN_syncr
PN_l1:
buffer_load_dwordx4 v[96:99], v234, s[8:11], s40 offen offset:0 nt
buffer_load_dwordx4 v[100:103], v234, s[8:11], s40 offen offset:128 nt
buffer_load_dwordx4 v[104:107], v234, s[8:11], s40 offen offset:256 nt
buffer_load_dwordx4 v[108:111], v234, s[8:11], s41 offen offset:0 nt
buffer_load_dwordx4 v[112:115], v234, s[8:11], s41 offen offset:128 nt
buffer_load_dwordx4 v[116:119], v234, s[8:11], s41 offen offset:256 nt
s_branch PN_lr1
PN_l2:
buffer_load_dwordx4 v[120:123], v234, s[8:11], s40 offen offset:0 nt
buffer_load_dwordx4 v[124:127], v234, s[8:11], s40 offen offset:128 nt
buffer_load_dwordx4 v[128:131], v234, s[8:11], s40 offen offset:256 nt
buffer_load_dwordx4 v[132:135], v234, s[8:11], s41 offen offset:0 nt
buffer_load_dwordx4 v[136:139], v234, s[8:11], s41 offen offset:128 nt
buffer_load_dwordx4 v[140:143], v234, s[8:11], s41 offen offset:256 nt
s_branch PN_lr2
PN_l0:
buffer_load_dwordx4 v[72:75], v234, s[8:11], s40 offen offset:0 nt
buffer_load_dwordx4 v[76:79], v234, s[8:11], s40 offen offset:128 nt
buffer_load_dwordx4 v[80:83], v234, s[8:11], s40 offen offset:256 nt
buffer_load_dwordx4 v[84:87], v234, s[8:11], s41 offen offset:0 nt
buffer_load_dwordx4 v[88:91], v234, s[8:11], s41 offen offset:128 nt
buffer_load_dwordx4 v[92:95], v234, s[8:11], s41 offen offset:256 nt
s_branch PN_lr0
C_pro2:
s_sub_u32 s25, s24, 4
s_and_b32 s26, s25, 1
s_lshr_b32 s27, s25, 1
s_mov_b32 s20, s70
s_mov_b32 s21, s71
s_mov_b32 s22, 402653184
s_mov_b32 s23, 0x20000
s_mov_b32 s8, s68
s_mov_b32 s9, s69
s_mov_b32 s10, 256
s_mov_b32 s11, 0x20000
s_and_b32 s3, s2, 7
s_lshl_b32 s3, s3, 5
s_lshr_b32 s4, s2, 3
s_add_u32 s3, s3, s4
s_sub_u32 s4, s2, 120
s_lshr_b32 s5, s4, 3
s_xor_b32 s6, s4, s5
s_and_b32 s6, s6, 7
s_cmp_eq_u32 s6, 0
s_cselect_b32 s5, s5, -1
s_cmp_lt_u32 s4, 128
s_cselect_b32 s5, s5, -1
s_lshl_b32 s33, s25, 2
s_add_u32 s33, s33, 158864
s_lshl_b32 s30, s26, 14
s_lshl_b32 s31, s27, 13
s_add_u32 s30, s30, s31
s_add_u32 s31, s30, 76032
s_cmp_eq_u32 s25, 3
s_cselect_b32 s31, 150528, s31
s_and_b32 s34, s2, 7
s_lshl_b32 s34, s34, 15
s_add_u32 s30, s30, s34
v_and_b32 v250, 31, v246
v_lshrrev_b32 v251, 5, v246
v_and_b32 v252, 2, v250
v_lshlrev_b32 v252, 1, v252
v_bfe_u32 v253, v250, 2, 2
v_or_b32 v252, v252, v253
v_xor_b32 v252, v252, v251
v_lshlrev_b32 v252, 4, v252
s_mul_i32 s35, s27, 12288
v_mul_u32_u24 v253, 384, v250
v_add_u32 v253, s35, v253
v_xor_b32 v232, 0, v252
v_add_u32 v232, v232, v253
v_xor_b32 v233, 32, v252
v_add_u32 v233, v233, v253
v_xor_b32 v234, 64, v252
v_add_u32 v234, v234, v253
v_xor_b32 v235, 96, v252
v_add_u32 v235, v235, v253
s_lshl_b32 s39, s27, 7
s_add_u32 s39, s39, 24576
v_lshl_add_u32 v241, v250, 2, s39
v_lshl_add_u32 v240, v251, 4, s39
v_bfe_u32 v250, v246, 4, 1
v_lshlrev_b32 v250, 1, v250
v_bfe_u32 v252, v246, 1, 1
v_or_b32 v250, v250, v252
v_bfe_u32 v252, v246, 3, 1
v_lshlrev_b32 v252, 2, v252
v_or_b32 v252, v252, v251
v_xor_b32 v250, v250, v252
v_lshlrev_b32 v250, 4, v250
v_bfe_u32 v252, v246, 2, 2
v_lshl_add_u32 v252, v251, 2, v252
v_mul_u32_u24 v252, 384, v252
v_and_b32 v253, 1, v246
v_lshl_add_u32 v252, v253, 3, v252
v_add_u32 v252, s35, v252
v_xor_b32 v236, 0, v250
v_add_u32 v236, v236, v252
v_xor_b32 v237, 32, v250
v_add_u32 v237, v237, v252
v_xor_b32 v238, 64, v250
v_add_u32 v238, v238, v252
v_xor_b32 v239, 96, v250
v_add_u32 v239, v239, v252
v_mov_b64 v[0:1], 0
v_mov_b64 v[2:3], 0
v_mov_b64 v[4:5], 0
v_mov_b64 v[6:7], 0
v_mov_b64 v[8:9], 0
v_mov_b64 v[10:11], 0
v_mov_b64 v[12:13], 0
v_mov_b64 v[14:15], 0
v_mov_b64 v[16:17], 0
v_mov_b64 v[18:19], 0
v_mov_b64 v[20:21], 0
v_mov_b64 v[22:23], 0
v_mov_b64 v[24:25], 0
v_mov_b64 v[26:27], 0
v_mov_b64 v[28:29], 0
v_mov_b64 v[30:31], 0
v_mov_b64 v[32:33], 0
v_mov_b64 v[34:35], 0
v_mov_b64 v[36:37], 0
v_mov_b64 v[38:39], 0
v_mov_b64 v[40:41], 0
v_mov_b64 v[42:43], 0
v_mov_b64 v[44:45], 0
v_mov_b64 v[46:47], 0
v_mov_b64 v[48:49], 0
v_mov_b64 v[50:51], 0
v_mov_b64 v[52:53], 0
v_mov_b64 v[54:55], 0
v_mov_b64 v[56:57], 0
v_mov_b64 v[58:59], 0
v_mov_b64 v[60:61], 0
v_mov_b64 v[62:63], 0
v_mov_b64 v[64:65], 0
v_mov_b64 v[66:67], 0
v_mov_b64 v[68:69], 0
v_mov_b64 v[70:71], 0
v_mov_b64 v[72:73], 0
v_mov_b64 v[74:75], 0
v_mov_b64 v[76:77], 0
v_mov_b64 v[78:79], 0
v_mov_b64 v[80:81], 0
v_mov_b64 v[82:83], 0
v_mov_b64 v[84:85], 0
v_mov_b64 v[86:87], 0
v_mov_b64 v[88:89], 0
v_mov_b64 v[90:91], 0
v_mov_b64 v[92:93], 0
v_mov_b64 v[94:95], 0
v_mov_b32 v247, 0
v_mov_b32 v248, 0
v_mov_b32 v249, 0
s_mov_b32 s36, 0xff800000
s_mov_b32 s37, 0xff800000
s_mov_b32 s39, 0
s_mov_b32 s47, 25344
s_cmp_eq_u32 s25, 3
s_cselect_b32 s28, 9, 99
s_cselect_b32 s29, 12, 99
s_sub_u32 s42, s2, 128
s_cmp_lt_u32 s42, 24
s_cselect_b32 s13, s25, 0
v_lshlrev_b32 v252, 2, v246
v_and_b32 v252, 31, v252
v_add_u32 v252, 158784, v252
FW25:
s_sleep 1
ds_read_b32 v253, v252
s_waitcnt lgkmcnt(0)
v_cmp_eq_u32 vcc, 1, v253
s_and_b32 s6, vcc_lo, 15
s_cmp_eq_u32 s6, 15
s_cbranch_scc0 FW25
C_nolat:
s_setprio 2
v_mov_b32 v250, s33
v_mov_b32 v251, 1
ds_write_b32 v250, v251
v_lshlrev_b32 v250, 4, v246
v_mov_b32 v251, 252
s_mov_b32 m0, s31
s_mov_b32 s34, s30
s_xor_b32 s30, s30, 262144
buffer_load_dwordx4 v250, s[20:23], s34 offen offset:0 sc1 lds
buffer_load_dwordx4 v250, s[20:23], s34 offen offset:1024 sc1 lds
buffer_load_dwordx4 v250, s[20:23], s34 offen offset:2048 sc1 lds
buffer_load_dwordx4 v250, s[20:23], s34 offen offset:3072 sc1 lds
s_add_u32 m0, s31, 4096
s_add_u32 s34, s34, 4096
buffer_load_dwordx4 v250, s[20:23], s34 offen offset:0 sc1 lds
buffer_load_dwordx4 v250, s[20:23], s34 offen offset:1024 sc1 lds
buffer_load_dwordx4 v250, s[20:23], s34 offen offset:2048 sc1 lds
buffer_load_dwordx4 v250, s[20:23], s34 offen offset:3072 sc1 lds
s_mov_b32 m0, s33
s_mov_b64 exec, 1
s_waitcnt lgkmcnt(0)
buffer_load_dword v251, s[8:11], 0 offen lds
s_mov_b64 exec, -1
s_barrier
C_wait:
s_xor_b32 s42, s33, 8
v_mov_b32 v250, s33
v_mov_b32 v251, s42
ds_read_b32 v252, v250
ds_read_b32 v253, v251
s_waitcnt lgkmcnt(0)
v_or_b32 v252, v252, v253
s_nop 0
v_readfirstlane_b32 s42, v252
s_cmp_eq_u32 s42, 0
s_cbranch_scc1 C_landed
C_again:
s_sleep 2
s_branch C_wait
C_landed:
s_lshl_b32 s42, s26, 14
s_add_u32 s42, s42, 76032
v_lshl_add_u32 v250, v246, 4, s42
s_add_u32 s42, s42, 8192
s_cmp_eq_u32 s26, 0
s_cselect_b32 s42, s42, 150528
v_lshl_add_u32 v251, v246, 4, s42
s_waitcnt vmcnt(0)
ds_read_b128 v[160:163], v250 offset:0
ds_read_b128 v[164:167], v250 offset:1024
ds_read_b128 v[168:171], v250 offset:2048
ds_read_b128 v[172:175], v250 offset:3072
ds_read_b128 v[176:179], v250 offset:4096
ds_read_b128 v[180:183], v250 offset:5120
ds_read_b128 v[184:187], v250 offset:6144
ds_read_b128 v[188:191], v250 offset:7168
ds_read_b128 v[192:195], v251 offset:0
ds_read_b128 v[196:199], v251 offset:1024
ds_read_b128 v[200:203], v251 offset:2048
ds_read_b128 v[204:207], v251 offset:3072
ds_read_b128 v[208:211], v251 offset:4096
ds_read_b128 v[212:215], v251 offset:5120
ds_read_b128 v[216:219], v251 offset:6144
ds_read_b128 v[220:223], v251 offset:7168
s_waitcnt lgkmcnt(12)
v_sub_u32 v144, v167, v163
v_sub_u32 v145, v175, v171
s_waitcnt lgkmcnt(8)
v_sub_u32 v146, v183, v179
v_sub_u32 v147, v191, v187
s_waitcnt lgkmcnt(4)
v_sub_u32 v148, v199, v195
v_sub_u32 v149, v207, v203
s_waitcnt lgkmcnt(0)
v_sub_u32 v150, v215, v211
v_sub_u32 v151, v223, v219
v_cmp_eq_u32 s[42:43], s7, v144
v_cmp_eq_u32 vcc, s7, v145
s_and_b64 s[42:43], s[42:43], vcc
v_cmp_eq_u32 vcc, s7, v146
s_and_b64 s[42:43], s[42:43], vcc
v_cmp_eq_u32 vcc, s7, v147
s_and_b64 s[42:43], s[42:43], vcc
v_cmp_eq_u32 s[44:45], s7, v148
v_cmp_eq_u32 vcc, s7, v149
s_and_b64 s[44:45], s[44:45], vcc
v_cmp_eq_u32 vcc, s7, v150
s_and_b64 s[44:45], s[44:45], vcc
v_cmp_eq_u32 vcc, s7, v151
s_and_b64 s[44:45], s[44:45], vcc
s_and_b64 vcc, s[42:43], s[44:45]
s_cmp_eq_u64 vcc, -1
s_cbranch_scc1 C_ready
s_cmp_eq_u32 s27, 0
s_cselect_b64 s[42:43], s[42:43], s[44:45]
s_cmp_eq_u64 s[42:43], -1
s_cbranch_scc1 C_again
v_mov_b32 v250, s33
v_mov_b32 v251, 1
ds_write_b32 v250, v251
v_lshlrev_b32 v250, 4, v246
v_mov_b32 v251, 252
s_mov_b32 m0, s31
s_mov_b32 s34, s30
s_xor_b32 s30, s30, 262144
buffer_load_dwordx4 v250, s[20:23], s34 offen offset:0 sc1 lds
buffer_load_dwordx4 v250, s[20:23], s34 offen offset:1024 sc1 lds
buffer_load_dwordx4 v250, s[20:23], s34 offen offset:2048 sc1 lds
buffer_load_dwordx4 v250, s[20:23], s34 offen offset:3072 sc1 lds
s_add_u32 m0, s31, 4096
s_add_u32 s34, s34, 4096
buffer_load_dwordx4 v250, s[20:23], s34 offen offset:0 sc1 lds
buffer_load_dwordx4 v250, s[20:23], s34 offen offset:1024 sc1 lds
buffer_load_dwordx4 v250, s[20:23], s34 offen offset:2048 sc1 lds
buffer_load_dwordx4 v250, s[20:23], s34 offen offset:3072 sc1 lds
s_mov_b32 m0, s33
s_mov_b64 exec, 1
s_waitcnt lgkmcnt(0)
buffer_load_dword v251, s[8:11], 0 offen lds
s_mov_b64 exec, -1
s_branch C_again
C_ready:
v_mov_b32 v96, v160
v_mov_b32 v97, v161
v_mov_b32 v100, v162
v_mov_b32 v101, v164
v_mov_b32 v104, v165
v_mov_b32 v105, v166
v_mov_b32 v98, v168
v_mov_b32 v99, v169
v_mov_b32 v102, v170
v_mov_b32 v103, v172
v_mov_b32 v106, v173
v_mov_b32 v107, v174
v_mov_b32 v108, v176
v_mov_b32 v109, v177
v_mov_b32 v112, v178
v_mov_b32 v113, v180
v_mov_b32 v116, v181
v_mov_b32 v117, v182
v_mov_b32 v110, v184
v_mov_b32 v111, v185
v_mov_b32 v114, v186
v_mov_b32 v115, v188
v_mov_b32 v118, v189
v_mov_b32 v119, v190
v_mov_b32 v120, v192
v_mov_b32 v121, v193
v_mov_b32 v124, v194
v_mov_b32 v125, v196
v_mov_b32 v128, v197
v_mov_b32 v129, v198
v_mov_b32 v122, v200
v_mov_b32 v123, v201
v_mov_b32 v126, v202
v_mov_b32 v127, v204
v_mov_b32 v130, v205
v_mov_b32 v131, v206
v_mov_b32 v132, v208
v_mov_b32 v133, v209
v_mov_b32 v136, v210
v_mov_b32 v137, v212
v_mov_b32 v140, v213
v_mov_b32 v141, v214
v_mov_b32 v134, v216
v_mov_b32 v135, v217
v_mov_b32 v138, v218
v_mov_b32 v139, v220
v_mov_b32 v142, v221
v_mov_b32 v143, v222
v_add_f32 v163, v163, v195
v_add_f32 v171, v171, v203
v_add_f32 v179, v179, v211
v_add_f32 v187, v187, v219
v_add_f32 v163, v163, v171
v_add_f32 v179, v179, v187
v_add_f32 v250, v163, v179
v_add_f32 v251, v163, v179
s_mov_b32 vcc_lo, -1
s_mov_b32 vcc_hi, 0
v_permlane32_swap_b32 v250, v251
v_add_f32 v250, v250, v251
v_sub_f32 v250, 0, v250
v_cvt_pk_bf16_f32 v251, v250, v250
v_and_b32 v252, 0xffff0000, v251
v_sub_f32 v252, v250, v252
v_cvt_pk_bf16_f32 v252, v252, 0
v_cndmask_b32 v244, 0, v251, vcc
v_cndmask_b32 v245, 0, v252, vcc
s_cmp_eq_u32 s13, 3
s_cbranch_scc0 C_bar0
v_mov_b32 v217, 0
v_mov_b32 v218, 1
s_mov_b64 exec, 1
buffer_atomic_add v218, v217, s[8:11], 0 offen
s_mov_b64 exec, -1
C_bar0:
s_barrier
C_tile:
ds_read2st64_b32 v[242:243], v241 offset0:1 offset1:2
ds_read_b128 v[184:187], v232 offset:0
ds_read_b128 v[188:191], v233 offset:0
ds_read_b128 v[192:195], v234 offset:0
ds_read_b128 v[196:199], v235 offset:0
ds_read_b128 v[200:203], v232 offset:128
ds_read_b128 v[204:207], v233 offset:128
ds_read_b128 v[208:211], v234 offset:128
ds_read_b128 v[212:215], v235 offset:128
ds_read_b128 v[216:219], v232 offset:256
ds_read_b128 v[220:223], v233 offset:256
ds_read_b128 v[224:227], v234 offset:256
ds_read_b128 v[228:231], v235 offset:256
s_add_u32 s39, s39, 1
s_and_b32 s45, s39, 3
s_cmp_eq_u32 s45, 0
s_cselect_b32 s45, 0xfffed700, s47
s_waitcnt lgkmcnt(12)
v_mfma_f32_32x32x8_bf16 v[160:175], v[242:243], v[244:245], 0
ds_read_b128 v[144:147], v240 offset:0
ds_read_b128 v[148:151], v240 offset:32
ds_read_b128 v[152:155], v240 offset:64
ds_read_b128 v[156:159], v240 offset:96
v_add_u32 v240, s45, v240
s_waitcnt lgkmcnt(15)
v_mfma_f32_32x32x16_bf16 v[160:175], v[184:187], v[96:99], v[160:175]
v_add_u32 v232, s45, v232
s_waitcnt lgkmcnt(14)
v_mfma_f32_32x32x16_bf16 v[160:175], v[188:191], v[100:103], v[160:175]
v_add_u32 v233, s45, v233
s_waitcnt lgkmcnt(13)
v_mfma_f32_32x32x16_bf16 v[160:175], v[192:195], v[104:107], v[160:175]
v_add_u32 v234, s45, v234
s_waitcnt lgkmcnt(12)
v_mfma_f32_32x32x16_bf16 v[160:175], v[196:199], v[108:111], v[160:175]
v_add_u32 v235, s45, v235
s_waitcnt lgkmcnt(11)
v_mfma_f32_32x32x16_bf16 v[160:175], v[200:203], v[112:115], v[160:175]
v_add_u32 v241, s45, v241
s_waitcnt lgkmcnt(10)
v_mfma_f32_32x32x16_bf16 v[160:175], v[204:207], v[116:119], v[160:175]
s_waitcnt lgkmcnt(9)
v_mfma_f32_32x32x16_bf16 v[160:175], v[208:211], v[120:123], v[160:175]
s_waitcnt lgkmcnt(8)
v_mfma_f32_32x32x16_bf16 v[160:175], v[212:215], v[124:127], v[160:175]
s_waitcnt lgkmcnt(7)
v_mfma_f32_32x32x16_bf16 v[160:175], v[216:219], v[128:131], v[160:175]
s_waitcnt lgkmcnt(6)
v_mfma_f32_32x32x16_bf16 v[160:175], v[220:223], v[132:135], v[160:175]
s_waitcnt lgkmcnt(5)
v_mfma_f32_32x32x16_bf16 v[160:175], v[224:227], v[136:139], v[160:175]
s_waitcnt lgkmcnt(4)
v_mfma_f32_32x32x16_bf16 v[160:175], v[228:231], v[140:143], v[160:175]
ds_read_b64_tr_b16 v[184:185], v236 offset:0
ds_read_b64_tr_b16 v[186:187], v237 offset:3072
ds_read_b64_tr_b16 v[188:189], v238 offset:0
ds_read_b64_tr_b16 v[190:191], v239 offset:3072
s_waitcnt lgkmcnt(4)
s_nop 6
v_fma_f32 v160, v160, v144, v247
v_fma_f32 v161, v161, v145, v247
ds_read_b64_tr_b16 v[192:193], v236 offset:128
ds_read_b64_tr_b16 v[194:195], v237 offset:3200
v_fma_f32 v162, v162, v146, v247
v_fma_f32 v163, v163, v147, v247
ds_read_b64_tr_b16 v[196:197], v238 offset:128
ds_read_b64_tr_b16 v[198:199], v239 offset:3200
v_fma_f32 v164, v164, v148, v247
v_fma_f32 v165, v165, v149, v247
ds_read_b64_tr_b16 v[200:201], v236 offset:256
ds_read_b64_tr_b16 v[202:203], v237 offset:3328
v_fma_f32 v166, v166, v150, v247
v_fma_f32 v167, v167, v151, v247
ds_read_b64_tr_b16 v[204:205], v238 offset:256
ds_read_b64_tr_b16 v[206:207], v239 offset:3328
v_fma_f32 v168, v168, v152, v247
v_fma_f32 v169, v169, v153, v247
ds_read_b64_tr_b16 v[208:209], v236 offset:6144
ds_read_b64_tr_b16 v[210:211], v237 offset:9216
v_fma_f32 v170, v170, v154, v247
v_fma_f32 v171, v171, v155, v247
ds_read_b64_tr_b16 v[212:213], v238 offset:6144
ds_read_b64_tr_b16 v[214:215], v239 offset:9216
v_fma_f32 v172, v172, v156, v247
v_fma_f32 v173, v173, v157, v247
ds_read_b64_tr_b16 v[216:217], v236 offset:6272
ds_read_b64_tr_b16 v[218:219], v237 offset:9344
v_fma_f32 v174, v174, v158, v247
v_fma_f32 v175, v175, v159, v247
ds_read_b64_tr_b16 v[220:221], v238 offset:6272
ds_read_b64_tr_b16 v[222:223], v239 offset:9344
v_max3_f32 v250, v160, v161, v162
v_max3_f32 v251, v163, v164, v165
ds_read_b64_tr_b16 v[224:225], v236 offset:6400
ds_read_b64_tr_b16 v[226:227], v237 offset:9472
v_max3_f32 v250, v250, v166, v167
v_max3_f32 v251, v251, v168, v169
ds_read_b64_tr_b16 v[228:229], v238 offset:6400
ds_read_b64_tr_b16 v[230:231], v239 offset:9472
v_max3_f32 v250, v250, v170, v171
v_max3_f32 v251, v251, v172, v173
v_max3_f32 v250, v250, v174, v175
v_max_f32 v250, v250, v251
v_cmp_lt_f32 vcc, s36, v250
s_cbranch_vccnz C_rescale
C_norescale:
v_exp_f32 v160, v160
v_exp_f32 v161, v161
v_exp_f32 v162, v162
v_exp_f32 v163, v163
v_exp_f32 v164, v164
v_exp_f32 v165, v165
v_exp_f32 v166, v166
v_exp_f32 v167, v167
v_mul_f32 v144, v144, v160
v_mul_f32 v145, v145, v161
v_mul_f32 v146, v146, v162
v_mul_f32 v147, v147, v163
v_mul_f32 v148, v148, v164
v_mul_f32 v149, v149, v165
v_mul_f32 v150, v150, v166
v_mul_f32 v151, v151, v167
v_cvt_pk_bf16_f32 v176, v144, v145
v_cvt_pk_bf16_f32 v177, v146, v147
v_cvt_pk_bf16_f32 v178, v148, v149
v_cvt_pk_bf16_f32 v179, v150, v151
v_add_u32 v236, s45, v236
v_add_u32 v237, s45, v237
v_add_u32 v238, s45, v238
v_add_u32 v239, s45, v239
s_waitcnt lgkmcnt(15)
s_nop 0
v_mfma_f32_32x32x16_bf16 v[0:15], v[184:187], v[176:179], v[0:15]
v_exp_f32 v168, v168
v_exp_f32 v169, v169
v_exp_f32 v170, v170
s_waitcnt lgkmcnt(15)
v_mfma_f32_32x32x16_bf16 v[16:31], v[188:191], v[176:179], v[16:31]
v_exp_f32 v171, v171
v_exp_f32 v172, v172
v_exp_f32 v173, v173
s_waitcnt lgkmcnt(15)
v_mfma_f32_32x32x16_bf16 v[32:47], v[192:195], v[176:179], v[32:47]
v_exp_f32 v174, v174
v_exp_f32 v175, v175
v_mul_f32 v152, v152, v168
v_mul_f32 v153, v153, v169
s_waitcnt lgkmcnt(15)
v_mfma_f32_32x32x16_bf16 v[48:63], v[196:199], v[176:179], v[48:63]
v_mul_f32 v154, v154, v170
v_mul_f32 v155, v155, v171
v_mul_f32 v156, v156, v172
v_mul_f32 v157, v157, v173
v_mul_f32 v158, v158, v174
v_mul_f32 v159, v159, v175
s_waitcnt lgkmcnt(14)
v_mfma_f32_32x32x16_bf16 v[64:79], v[200:203], v[176:179], v[64:79]
v_cvt_pk_bf16_f32 v180, v152, v153
v_cvt_pk_bf16_f32 v181, v154, v155
v_cvt_pk_bf16_f32 v182, v156, v157
v_cvt_pk_bf16_f32 v183, v158, v159
s_waitcnt lgkmcnt(12)
v_mfma_f32_32x32x16_bf16 v[80:95], v[204:207], v[176:179], v[80:95]
v_add_f32 v248, v248, v160
v_add_f32 v249, v249, v161
v_add_f32 v248, v248, v162
v_add_f32 v249, v249, v163
s_waitcnt lgkmcnt(0)
s_cmp_eq_u32 s39, 16
s_cbranch_scc1 C_final
v_mfma_f32_32x32x16_bf16 v[0:15], v[208:211], v[180:183], v[0:15]
v_add_f32 v248, v248, v164
v_add_f32 v249, v249, v165
v_add_f32 v248, v248, v166
v_add_f32 v249, v249, v167
v_mfma_f32_32x32x16_bf16 v[16:31], v[212:215], v[180:183], v[16:31]
v_add_f32 v248, v248, v168
v_add_f32 v249, v249, v169
v_add_f32 v248, v248, v170
v_add_f32 v249, v249, v171
v_mfma_f32_32x32x16_bf16 v[32:47], v[216:219], v[180:183], v[32:47]
v_add_f32 v248, v248, v172
v_add_f32 v249, v249, v173
v_add_f32 v248, v248, v174
v_add_f32 v249, v249, v175
v_mfma_f32_32x32x16_bf16 v[48:63], v[220:223], v[180:183], v[48:63]
v_mfma_f32_32x32x16_bf16 v[64:79], v[224:227], v[180:183], v[64:79]
v_mfma_f32_32x32x16_bf16 v[80:95], v[228:231], v[180:183], v[80:95]
s_cmp_eq_u32 s39, s28
s_cbranch_scc1 C_poll
s_cmp_eq_u32 s39, s29
s_cbranch_scc1 C_chk
C_bar:
s_barrier
s_branch C_tile
C_poll:
v_mov_b32 v250, 0
s_mov_b32 m0, 158848
s_mov_b64 exec, 1
buffer_load_dword v250, s[8:11], 0 offen sc1 lds
s_mov_b64 exec, -1
s_branch C_bar
C_chk:
s_waitcnt vmcnt(0)
v_mov_b32 v250, 158848
ds_read_b32 v252, v250
s_waitcnt lgkmcnt(0)
v_readfirstlane_b32 s42, v252
s_cmp_ge_u32 s42, 24
s_cbranch_scc1 C_bar
s_sleep 8
v_mov_b32 v250, 0
s_mov_b32 m0, 158848
s_mov_b64 exec, 1
buffer_load_dword v250, s[8:11], 0 offen sc1 lds
s_mov_b64 exec, -1
s_branch C_chk
C_rescale:
v_mov_b32 v251, v250
s_nop 1
v_permlane32_swap_b32 v250, v251
v_max_f32 v250, v250, v251
v_max_f32 v250, s37, v250
v_max_f32 v251, 0, v250
v_exp_f32 v252, -v251
s_mov_b32 s36, 0x42000000
s_mov_b32 s37, 0
v_sub_f32 v160, v160, v250
v_sub_f32 v161, v161, v250
v_sub_f32 v162, v162, v250
v_sub_f32 v163, v163, v250
v_sub_f32 v164, v164, v250
v_sub_f32 v165, v165, v250
v_sub_f32 v166, v166, v250
v_sub_f32 v167, v167, v250
v_sub_f32 v168, v168, v250
v_sub_f32 v169, v169, v250
v_sub_f32 v170, v170, v250
v_sub_f32 v171, v171, v250
v_sub_f32 v172, v172, v250
v_sub_f32 v173, v173, v250
v_sub_f32 v174, v174, v250
v_sub_f32 v175, v175, v250
v_sub_f32 v247, v247, v250
s_cmp_eq_u32 s39, 1
s_cbranch_scc1 C_norescale
v_mul_f32 v0, v0, v252
v_mul_f32 v1, v1, v252
v_mul_f32 v2, v2, v252
v_mul_f32 v3, v3, v252
v_mul_f32 v4, v4, v252
v_mul_f32 v5, v5, v252
v_mul_f32 v6, v6, v252
v_mul_f32 v7, v7, v252
v_mul_f32 v8, v8, v252
v_mul_f32 v9, v9, v252
v_mul_f32 v10, v10, v252
v_mul_f32 v11, v11, v252
v_mul_f32 v12, v12, v252
v_mul_f32 v13, v13, v252
v_mul_f32 v14, v14, v252
v_mul_f32 v15, v15, v252
v_mul_f32 v16, v16, v252
v_mul_f32 v17, v17, v252
v_mul_f32 v18, v18, v252
v_mul_f32 v19, v19, v252
v_mul_f32 v20, v20, v252
v_mul_f32 v21, v21, v252
v_mul_f32 v22, v22, v252
v_mul_f32 v23, v23, v252
v_mul_f32 v24, v24, v252
v_mul_f32 v25, v25, v252
v_mul_f32 v26, v26, v252
v_mul_f32 v27, v27, v252
v_mul_f32 v28, v28, v252
v_mul_f32 v29, v29, v252
v_mul_f32 v30, v30, v252
v_mul_f32 v31, v31, v252
v_mul_f32 v32, v32, v252
v_mul_f32 v33, v33, v252
v_mul_f32 v34, v34, v252
v_mul_f32 v35, v35, v252
v_mul_f32 v36, v36, v252
v_mul_f32 v37, v37, v252
v_mul_f32 v38, v38, v252
v_mul_f32 v39, v39, v252
v_mul_f32 v40, v40, v252
v_mul_f32 v41, v41, v252
v_mul_f32 v42, v42, v252
v_mul_f32 v43, v43, v252
v_mul_f32 v44, v44, v252
v_mul_f32 v45, v45, v252
v_mul_f32 v46, v46, v252
v_mul_f32 v47, v47, v252
v_mul_f32 v48, v48, v252
v_mul_f32 v49, v49, v252
v_mul_f32 v50, v50, v252
v_mul_f32 v51, v51, v252
v_mul_f32 v52, v52, v252
v_mul_f32 v53, v53, v252
v_mul_f32 v54, v54, v252
v_mul_f32 v55, v55, v252
v_mul_f32 v56, v56, v252
v_mul_f32 v57, v57, v252
v_mul_f32 v58, v58, v252
v_mul_f32 v59, v59, v252
v_mul_f32 v60, v60, v252
v_mul_f32 v61, v61, v252
v_mul_f32 v62, v62, v252
v_mul_f32 v63, v63, v252
v_mul_f32 v64, v64, v252
v_mul_f32 v65, v65, v252
v_mul_f32 v66, v66, v252
v_mul_f32 v67, v67, v252
v_mul_f32 v68, v68, v252
v_mul_f32 v69, v69, v252
v_mul_f32 v70, v70, v252
v_mul_f32 v71, v71, v252
v_mul_f32 v72, v72, v252
v_mul_f32 v73, v73, v252
v_mul_f32 v74, v74, v252
v_mul_f32 v75, v75, v252
v_mul_f32 v76, v76, v252
v_mul_f32 v77, v77, v252
v_mul_f32 v78, v78, v252
v_mul_f32 v79, v79, v252
v_mul_f32 v80, v80, v252
v_mul_f32 v81, v81, v252
v_mul_f32 v82, v82, v252
v_mul_f32 v83, v83, v252
v_mul_f32 v84, v84, v252
v_mul_f32 v85, v85, v252
v_mul_f32 v86, v86, v252
v_mul_f32 v87, v87, v252
v_mul_f32 v88, v88, v252
v_mul_f32 v89, v89, v252
v_mul_f32 v90, v90, v252
v_mul_f32 v91, v91, v252
v_mul_f32 v92, v92, v252
v_mul_f32 v93, v93, v252
v_mul_f32 v94, v94, v252
v_mul_f32 v95, v95, v252
v_mul_f32 v248, v248, v252
v_mul_f32 v249, v249, v252
s_branch C_norescale
C_final:
v_mfma_f32_32x32x16_bf16 v[0:15], v[208:211], v[180:183], v[0:15]
v_add_f32 v248, v248, v164
v_add_f32 v249, v249, v165
v_add_f32 v248, v248, v166
v_add_f32 v249, v249, v167
v_add_f32 v248, v248, v168
v_add_f32 v249, v249, v169
v_mfma_f32_32x32x16_bf16 v[16:31], v[212:215], v[180:183], v[16:31]
v_add_f32 v248, v248, v170
v_add_f32 v249, v249, v171
v_add_f32 v248, v248, v172
v_add_f32 v249, v249, v173
v_add_f32 v248, v248, v174
v_add_f32 v249, v249, v175
v_mfma_f32_32x32x16_bf16 v[32:47], v[216:219], v[180:183], v[32:47]
v_lshrrev_b32 v251, 5, v246
v_bfe_u32 v232, v246, 4, 1
v_mul_u32_u24 v232, 6144, v232
v_lshl_add_u32 v232, v251, 9, v232
v_and_b32 v252, 15, v246
v_lshl_add_u32 v232, v252, 4, v232
s_mul_i32 s39, s27, 24576
s_mul_i32 s40, s26, 12288
s_add_u32 s39, s39, s40
s_add_u32 s39, s39, 101376
v_add_u32 v232, s39, v232
v_and_b32 v250, 31, v246
v_lshlrev_b32 v233, 5, v250
v_lshl_add_u32 v233, v251, 3, v233
s_lshl_b32 s39, s26, 10
s_lshl_b32 s40, s27, 4
s_add_u32 s39, s39, s40
s_add_u32 s39, s39, 150528
v_add_u32 v233, s39, v233
v_mfma_f32_32x32x16_bf16 v[48:63], v[220:223], v[180:183], v[48:63]
v_cvt_pk_bf16_f32 v184, v0, v1
v_cvt_pk_bf16_f32 v185, v2, v3
v_cvt_pk_bf16_f32 v186, v4, v5
v_cvt_pk_bf16_f32 v187, v6, v7
ds_write_b128 v232, v[184:187] offset:0
v_cvt_pk_bf16_f32 v188, v8, v9
v_cvt_pk_bf16_f32 v189, v10, v11
v_cvt_pk_bf16_f32 v190, v12, v13
v_cvt_pk_bf16_f32 v191, v14, v15
ds_write_b128 v232, v[188:191] offset:256
v_mfma_f32_32x32x16_bf16 v[64:79], v[224:227], v[180:183], v[64:79]
v_cvt_pk_bf16_f32 v192, v16, v17
v_cvt_pk_bf16_f32 v193, v18, v19
v_cvt_pk_bf16_f32 v194, v20, v21
v_cvt_pk_bf16_f32 v195, v22, v23
ds_write_b128 v232, v[192:195] offset:1024
v_cvt_pk_bf16_f32 v196, v24, v25
v_cvt_pk_bf16_f32 v197, v26, v27
v_cvt_pk_bf16_f32 v198, v28, v29
v_cvt_pk_bf16_f32 v199, v30, v31
ds_write_b128 v232, v[196:199] offset:1280
v_mfma_f32_32x32x16_bf16 v[80:95], v[228:231], v[180:183], v[80:95]
v_cvt_pk_bf16_f32 v200, v32, v33
v_cvt_pk_bf16_f32 v201, v34, v35
v_cvt_pk_bf16_f32 v202, v36, v37
v_cvt_pk_bf16_f32 v203, v38, v39
ds_write_b128 v232, v[200:203] offset:2048
v_cvt_pk_bf16_f32 v204, v40, v41
v_cvt_pk_bf16_f32 v205, v42, v43
v_cvt_pk_bf16_f32 v206, v44, v45
v_cvt_pk_bf16_f32 v207, v46, v47
ds_write_b128 v232, v[204:207] offset:2304
v_add_f32 v249, v248, v249
v_sub_f32 v248, 0, v247
ds_write_b64 v233, v[248:249]
v_cvt_pk_bf16_f32 v184, v48, v49
v_cvt_pk_bf16_f32 v185, v50, v51
v_cvt_pk_bf16_f32 v186, v52, v53
v_cvt_pk_bf16_f32 v187, v54, v55
ds_write_b128 v232, v[184:187] offset:3072
v_cvt_pk_bf16_f32 v188, v56, v57
v_cvt_pk_bf16_f32 v189, v58, v59
v_cvt_pk_bf16_f32 v190, v60, v61
v_cvt_pk_bf16_f32 v191, v62, v63
ds_write_b128 v232, v[188:191] offset:3328
v_cvt_pk_bf16_f32 v192, v64, v65
v_cvt_pk_bf16_f32 v193, v66, v67
v_cvt_pk_bf16_f32 v194, v68, v69
v_cvt_pk_bf16_f32 v195, v70, v71
ds_write_b128 v232, v[192:195] offset:4096
v_cvt_pk_bf16_f32 v196, v72, v73
v_cvt_pk_bf16_f32 v197, v74, v75
v_cvt_pk_bf16_f32 v198, v76, v77
v_cvt_pk_bf16_f32 v199, v78, v79
ds_write_b128 v232, v[196:199] offset:4352
v_cvt_pk_bf16_f32 v200, v80, v81
v_cvt_pk_bf16_f32 v201, v82, v83
v_cvt_pk_bf16_f32 v202, v84, v85
v_cvt_pk_bf16_f32 v203, v86, v87
ds_write_b128 v232, v[200:203] offset:5120
v_cvt_pk_bf16_f32 v204, v88, v89
v_cvt_pk_bf16_f32 v205, v90, v91
v_cvt_pk_bf16_f32 v206, v92, v93
v_cvt_pk_bf16_f32 v207, v94, v95
ds_write_b128 v232, v[204:207] offset:5376
s_waitcnt lgkmcnt(0)
s_barrier
v_mov_b32 v0, v246
s_cmp_lt_i32 s5, 0
s_cbranch_scc0 FIN
s_endpgm
FIN:
v_and_b32 v3, 15, v0
v_lshrrev_b32 v2, 4, v0
v_bfe_u32 v6, v0, 3, 2
v_bfe_u32 v4, v0, 1, 2
v_lshlrev_b32 v5, 4, v0
s_lshl_b32 s10, s5, 17
s_lshl_b32 s11, s24, 14
s_add_u32 s10, s10, s11
s_add_u32 s10, s10, 786432
s_add_u32 s11, s10, 4096
s_add_u32 s12, s10, 8192
s_add_u32 s13, s10, 12288
v_lshrrev_b32 v1, 1, v0
v_lshlrev_b32 v1, 9, v1
v_and_b32 v7, 1, v0
v_lshl_add_u32 v1, v7, 4, v1
v_mul_u32_u24 v102, 48, v6
v_lshl_add_u32 v102, v4, 2, v102
v_lshrrev_b32 v103, 5, v0
v_add_u32 v102, v102, v103
v_mad_u32_u24 v102, v7, 18, v102
s_mul_i32 s25, s24, 768
v_lshl_add_u32 v4, v102, 2, s25
v_mad_u32_u24 v7, v7, 48, v4
s_lshl_b32 s25, s24, 3
v_lshl_add_u32 v6, v6, 6, s25
v_mov_b64 v[88:89], 0
v_mov_b64 v[90:91], 0
v_mov_b64 v[92:93], 0
v_mov_b64 v[94:95], 0
v_mov_b64 v[96:97], 0
v_mov_b64 v[98:99], 0
s_mov_b32 s26, 0
s_mov_b32 s33, 0
s_barrier
s_mov_b32 s44, 0x55555555
s_mov_b32 s45, s44
buffer_load_dwordx4 v[8:11], v5, s[20:23], s10 offen offset:0 sc1
buffer_load_dwordx4 v[12:15], v5, s[20:23], s10 offen offset:1024 sc1
buffer_load_dwordx4 v[16:19], v5, s[20:23], s10 offen offset:2048 sc1
buffer_load_dwordx4 v[20:23], v5, s[20:23], s10 offen offset:3072 sc1
buffer_load_dwordx4 v[24:27], v5, s[20:23], s11 offen offset:0 sc1
buffer_load_dwordx4 v[28:31], v5, s[20:23], s11 offen offset:1024 sc1
buffer_load_dwordx4 v[32:35], v5, s[20:23], s11 offen offset:2048 sc1
buffer_load_dwordx4 v[36:39], v5, s[20:23], s11 offen offset:3072 sc1
buffer_load_dwordx4 v[40:43], v5, s[20:23], s12 offen offset:0 sc1
buffer_load_dwordx4 v[44:47], v5, s[20:23], s12 offen offset:1024 sc1
buffer_load_dwordx4 v[48:51], v5, s[20:23], s12 offen offset:2048 sc1
buffer_load_dwordx4 v[52:55], v5, s[20:23], s12 offen offset:3072 sc1
buffer_load_dwordx4 v[56:59], v5, s[20:23], s13 offen offset:0 sc1
buffer_load_dwordx4 v[60:63], v5, s[20:23], s13 offen offset:1024 sc1
buffer_load_dwordx4 v[64:67], v5, s[20:23], s13 offen offset:2048 sc1
buffer_load_dwordx4 v[68:71], v5, s[20:23], s13 offen offset:3072 sc1
F_miss:
s_waitcnt vmcnt(0)
s_mov_b32 s26, 0xff
v_sub_u32_dpp v72, v11, v11 quad_perm:[1,0,3,2] row_mask:0xf bank_mask:0xf
v_sub_u32_dpp v73, v15, v15 quad_perm:[1,0,3,2] row_mask:0xf bank_mask:0xf
v_sub_u32_dpp v74, v19, v19 quad_perm:[1,0,3,2] row_mask:0xf bank_mask:0xf
v_sub_u32_dpp v75, v23, v23 quad_perm:[1,0,3,2] row_mask:0xf bank_mask:0xf
v_sub_u32_dpp v76, v27, v27 quad_perm:[1,0,3,2] row_mask:0xf bank_mask:0xf
v_sub_u32_dpp v77, v31, v31 quad_perm:[1,0,3,2] row_mask:0xf bank_mask:0xf
v_sub_u32_dpp v78, v35, v35 quad_perm:[1,0,3,2] row_mask:0xf bank_mask:0xf
v_sub_u32_dpp v79, v39, v39 quad_perm:[1,0,3,2] row_mask:0xf bank_mask:0xf
v_sub_u32_dpp v80, v43, v43 quad_perm:[1,0,3,2] row_mask:0xf bank_mask:0xf
v_sub_u32_dpp v81, v47, v47 quad_perm:[1,0,3,2] row_mask:0xf bank_mask:0xf
v_sub_u32_dpp v82, v51, v51 quad_perm:[1,0,3,2] row_mask:0xf bank_mask:0xf
v_sub_u32_dpp v83, v55, v55 quad_perm:[1,0,3,2] row_mask:0xf bank_mask:0xf
v_sub_u32_dpp v84, v59, v59 quad_perm:[1,0,3,2] row_mask:0xf bank_mask:0xf
v_sub_u32_dpp v85, v63, v63 quad_perm:[1,0,3,2] row_mask:0xf bank_mask:0xf
v_sub_u32_dpp v86, v67, v67 quad_perm:[1,0,3,2] row_mask:0xf bank_mask:0xf
v_sub_u32_dpp v87, v71, v71 quad_perm:[1,0,3,2] row_mask:0xf bank_mask:0xf
v_cmp_ne_u32 s[48:49], s7, v72
v_cmp_ne_u32 s[50:51], s7, v73
v_cmp_ne_u32 s[52:53], s7, v74
v_cmp_ne_u32 s[54:55], s7, v75
v_cmp_ne_u32 s[56:57], s7, v76
v_cmp_ne_u32 s[58:59], s7, v77
v_cmp_ne_u32 s[60:61], s7, v78
v_cmp_ne_u32 s[62:63], s7, v79
v_cmp_ne_u32 s[64:65], s7, v80
v_cmp_ne_u32 s[66:67], s7, v81
v_cmp_ne_u32 s[28:29], s7, v82
v_cmp_ne_u32 s[30:31], s7, v83
v_cmp_ne_u32 s[34:35], s7, v84
v_cmp_ne_u32 s[36:37], s7, v85
v_cmp_ne_u32 s[40:41], s7, v86
v_cmp_ne_u32 s[42:43], s7, v87
s_and_b64 s[48:49], s[48:49], s[44:45]
s_cbranch_scc0 F_v0
s_lshl_b64 vcc, s[48:49], 1
s_or_b64 exec, vcc, s[48:49]
s_mov_b32 s26, 0
buffer_load_dwordx4 v[8:11], v5, s[20:23], s10 offen offset:0 sc1
s_mov_b64 exec, -1
F_v0:
s_and_b64 s[50:51], s[50:51], s[44:45]
s_cbranch_scc0 F_v1
s_lshl_b64 vcc, s[50:51], 1
s_or_b64 exec, vcc, s[50:51]
s_mov_b32 s26, 0
buffer_load_dwordx4 v[12:15], v5, s[20:23], s10 offen offset:1024 sc1
s_mov_b64 exec, -1
F_v1:
s_and_b64 s[52:53], s[52:53], s[44:45]
s_cbranch_scc0 F_v2
s_lshl_b64 vcc, s[52:53], 1
s_or_b64 exec, vcc, s[52:53]
s_mov_b32 s26, 0
buffer_load_dwordx4 v[16:19], v5, s[20:23], s10 offen offset:2048 sc1
s_mov_b64 exec, -1
F_v2:
s_and_b64 s[54:55], s[54:55], s[44:45]
s_cbranch_scc0 F_v3
s_lshl_b64 vcc, s[54:55], 1
s_or_b64 exec, vcc, s[54:55]
s_mov_b32 s26, 0
buffer_load_dwordx4 v[20:23], v5, s[20:23], s10 offen offset:3072 sc1
s_mov_b64 exec, -1
F_v3:
s_and_b64 s[56:57], s[56:57], s[44:45]
s_cbranch_scc0 F_v4
s_lshl_b64 vcc, s[56:57], 1
s_or_b64 exec, vcc, s[56:57]
s_mov_b32 s26, 0
buffer_load_dwordx4 v[24:27], v5, s[20:23], s11 offen offset:0 sc1
s_mov_b64 exec, -1
F_v4:
s_and_b64 s[58:59], s[58:59], s[44:45]
s_cbranch_scc0 F_v5
s_lshl_b64 vcc, s[58:59], 1
s_or_b64 exec, vcc, s[58:59]
s_mov_b32 s26, 0
buffer_load_dwordx4 v[28:31], v5, s[20:23], s11 offen offset:1024 sc1
s_mov_b64 exec, -1
F_v5:
s_and_b64 s[60:61], s[60:61], s[44:45]
s_cbranch_scc0 F_v6
s_lshl_b64 vcc, s[60:61], 1
s_or_b64 exec, vcc, s[60:61]
s_mov_b32 s26, 0
buffer_load_dwordx4 v[32:35], v5, s[20:23], s11 offen offset:2048 sc1
s_mov_b64 exec, -1
F_v6:
s_and_b64 s[62:63], s[62:63], s[44:45]
s_cbranch_scc0 F_v7
s_lshl_b64 vcc, s[62:63], 1
s_or_b64 exec, vcc, s[62:63]
s_mov_b32 s26, 0
buffer_load_dwordx4 v[36:39], v5, s[20:23], s11 offen offset:3072 sc1
s_mov_b64 exec, -1
F_v7:
s_and_b64 s[64:65], s[64:65], s[44:45]
s_cbranch_scc0 F_v8
s_lshl_b64 vcc, s[64:65], 1
s_or_b64 exec, vcc, s[64:65]
s_mov_b32 s26, 0
buffer_load_dwordx4 v[40:43], v5, s[20:23], s12 offen offset:0 sc1
s_mov_b64 exec, -1
F_v8:
s_and_b64 s[66:67], s[66:67], s[44:45]
s_cbranch_scc0 F_v9
s_lshl_b64 vcc, s[66:67], 1
s_or_b64 exec, vcc, s[66:67]
s_mov_b32 s26, 0
buffer_load_dwordx4 v[44:47], v5, s[20:23], s12 offen offset:1024 sc1
s_mov_b64 exec, -1
F_v9:
s_and_b64 s[28:29], s[28:29], s[44:45]
s_cbranch_scc0 F_v10
s_lshl_b64 vcc, s[28:29], 1
s_or_b64 exec, vcc, s[28:29]
s_mov_b32 s26, 0
buffer_load_dwordx4 v[48:51], v5, s[20:23], s12 offen offset:2048 sc1
s_mov_b64 exec, -1
F_v10:
s_and_b64 s[30:31], s[30:31], s[44:45]
s_cbranch_scc0 F_v11
s_lshl_b64 vcc, s[30:31], 1
s_or_b64 exec, vcc, s[30:31]
s_mov_b32 s26, 0
buffer_load_dwordx4 v[52:55], v5, s[20:23], s12 offen offset:3072 sc1
s_mov_b64 exec, -1
F_v11:
s_and_b64 s[34:35], s[34:35], s[44:45]
s_cbranch_scc0 F_v12
s_lshl_b64 vcc, s[34:35], 1
s_or_b64 exec, vcc, s[34:35]
s_mov_b32 s26, 0
buffer_load_dwordx4 v[56:59], v5, s[20:23], s13 offen offset:0 sc1
s_mov_b64 exec, -1
F_v12:
s_and_b64 s[36:37], s[36:37], s[44:45]
s_cbranch_scc0 F_v13
s_lshl_b64 vcc, s[36:37], 1
s_or_b64 exec, vcc, s[36:37]
s_mov_b32 s26, 0
buffer_load_dwordx4 v[60:63], v5, s[20:23], s13 offen offset:1024 sc1
s_mov_b64 exec, -1
F_v13:
s_and_b64 s[40:41], s[40:41], s[44:45]
s_cbranch_scc0 F_v14
s_lshl_b64 vcc, s[40:41], 1
s_or_b64 exec, vcc, s[40:41]
s_mov_b32 s26, 0
buffer_load_dwordx4 v[64:67], v5, s[20:23], s13 offen offset:2048 sc1
s_mov_b64 exec, -1
F_v14:
s_and_b64 s[42:43], s[42:43], s[44:45]
s_cbranch_scc0 F_v15
s_lshl_b64 vcc, s[42:43], 1
s_or_b64 exec, vcc, s[42:43]
s_mov_b32 s26, 0
buffer_load_dwordx4 v[68:71], v5, s[20:23], s13 offen offset:3072 sc1
s_mov_b64 exec, -1
F_v15:
s_cmp_eq_u32 s26, 0xff
s_cbranch_scc0 F_miss
s_mov_b64 vcc, s[44:45]
v_cndmask_b32_dpp v72, v15, v11, vcc quad_perm:[0,0,2,2] row_mask:0xf bank_mask:0xf
v_cndmask_b32_dpp v74, v23, v19, vcc quad_perm:[0,0,2,2] row_mask:0xf bank_mask:0xf
v_cndmask_b32_dpp v76, v31, v27, vcc quad_perm:[0,0,2,2] row_mask:0xf bank_mask:0xf
v_cndmask_b32_dpp v78, v39, v35, vcc quad_perm:[0,0,2,2] row_mask:0xf bank_mask:0xf
v_cndmask_b32_dpp v80, v47, v43, vcc quad_perm:[0,0,2,2] row_mask:0xf bank_mask:0xf
v_cndmask_b32_dpp v82, v55, v51, vcc quad_perm:[0,0,2,2] row_mask:0xf bank_mask:0xf
v_cndmask_b32_dpp v84, v63, v59, vcc quad_perm:[0,0,2,2] row_mask:0xf bank_mask:0xf
v_cndmask_b32_dpp v86, v71, v67, vcc quad_perm:[0,0,2,2] row_mask:0xf bank_mask:0xf
v_max3_f32 v100, v72, v74, v76
v_max3_f32 v101, v78, v80, v82
v_max3_f32 v100, v100, v84, v86
v_max_f32 v100, v100, v101
s_nop 1
v_max_f32_dpp v100, v100, v100 quad_perm:[1,0,3,2] row_mask:0xf bank_mask:0xf
v_mov_b32 v101, v100
s_nop 1
v_permlane32_swap_b32 v100, v101
s_nop 1
v_max_f32 v100, v100, v101
v_sub_f32 v72, v72, v100
v_sub_f32 v74, v74, v100
v_sub_f32 v76, v76, v100
v_sub_f32 v78, v78, v100
v_sub_f32 v80, v80, v100
v_sub_f32 v82, v82, v100
v_sub_f32 v84, v84, v100
v_sub_f32 v86, v86, v100
v_exp_f32 v72, v72
v_exp_f32 v74, v74
v_exp_f32 v76, v76
v_exp_f32 v78, v78
v_exp_f32 v80, v80
v_exp_f32 v82, v82
v_exp_f32 v84, v84
v_exp_f32 v86, v86
v_cvt_pk_bf16_f32 v72, v72, 0
v_cvt_pk_bf16_f32 v74, v74, 0
v_cvt_pk_bf16_f32 v76, v76, 0
v_cvt_pk_bf16_f32 v78, v78, 0
v_cvt_pk_bf16_f32 v80, v80, 0
v_cvt_pk_bf16_f32 v82, v82, 0
v_cvt_pk_bf16_f32 v84, v84, 0
v_cvt_pk_bf16_f32 v86, v86, 0
v_lshlrev_b32 v73, 16, v72
v_lshlrev_b32 v75, 16, v74
v_lshlrev_b32 v77, 16, v76
v_lshlrev_b32 v79, 16, v78
v_lshlrev_b32 v81, 16, v80
v_lshlrev_b32 v83, 16, v82
v_lshlrev_b32 v85, 16, v84
v_lshlrev_b32 v87, 16, v86
v_dot2c_f32_bf16_dpp v88, v72, v8 quad_perm:[0,0,2,2] row_mask:0xf bank_mask:0xf
v_dot2c_f32_bf16_dpp v89, v73, v8 quad_perm:[0,0,2,2] row_mask:0xf bank_mask:0xf
v_dot2c_f32_bf16_dpp v90, v72, v9 quad_perm:[0,0,2,2] row_mask:0xf bank_mask:0xf
v_dot2c_f32_bf16_dpp v91, v73, v9 quad_perm:[0,0,2,2] row_mask:0xf bank_mask:0xf
v_dot2c_f32_bf16_dpp v92, v72, v10 quad_perm:[0,0,2,2] row_mask:0xf bank_mask:0xf
v_dot2c_f32_bf16_dpp v93, v73, v10 quad_perm:[0,0,2,2] row_mask:0xf bank_mask:0xf
v_dot2c_f32_bf16_dpp v94, v72, v12 quad_perm:[1,1,3,3] row_mask:0xf bank_mask:0xf
v_dot2c_f32_bf16_dpp v95, v73, v12 quad_perm:[1,1,3,3] row_mask:0xf bank_mask:0xf
v_dot2c_f32_bf16_dpp v96, v72, v13 quad_perm:[1,1,3,3] row_mask:0xf bank_mask:0xf
v_dot2c_f32_bf16_dpp v97, v73, v13 quad_perm:[1,1,3,3] row_mask:0xf bank_mask:0xf
v_dot2c_f32_bf16_dpp v98, v72, v14 quad_perm:[1,1,3,3] row_mask:0xf bank_mask:0xf
v_dot2c_f32_bf16_dpp v99, v73, v14 quad_perm:[1,1,3,3] row_mask:0xf bank_mask:0xf
v_dot2c_f32_bf16_dpp v88, v74, v16 quad_perm:[0,0,2,2] row_mask:0xf bank_mask:0xf
v_dot2c_f32_bf16_dpp v89, v75, v16 quad_perm:[0,0,2,2] row_mask:0xf bank_mask:0xf
v_dot2c_f32_bf16_dpp v90, v74, v17 quad_perm:[0,0,2,2] row_mask:0xf bank_mask:0xf
v_dot2c_f32_bf16_dpp v91, v75, v17 quad_perm:[0,0,2,2] row_mask:0xf bank_mask:0xf
v_dot2c_f32_bf16_dpp v92, v74, v18 quad_perm:[0,0,2,2] row_mask:0xf bank_mask:0xf
v_dot2c_f32_bf16_dpp v93, v75, v18 quad_perm:[0,0,2,2] row_mask:0xf bank_mask:0xf
v_dot2c_f32_bf16_dpp v94, v74, v20 quad_perm:[1,1,3,3] row_mask:0xf bank_mask:0xf
v_dot2c_f32_bf16_dpp v95, v75, v20 quad_perm:[1,1,3,3] row_mask:0xf bank_mask:0xf
v_dot2c_f32_bf16_dpp v96, v74, v21 quad_perm:[1,1,3,3] row_mask:0xf bank_mask:0xf
v_dot2c_f32_bf16_dpp v97, v75, v21 quad_perm:[1,1,3,3] row_mask:0xf bank_mask:0xf
v_dot2c_f32_bf16_dpp v98, v74, v22 quad_perm:[1,1,3,3] row_mask:0xf bank_mask:0xf
v_dot2c_f32_bf16_dpp v99, v75, v22 quad_perm:[1,1,3,3] row_mask:0xf bank_mask:0xf
v_dot2c_f32_bf16_dpp v88, v76, v24 quad_perm:[0,0,2,2] row_mask:0xf bank_mask:0xf
v_dot2c_f32_bf16_dpp v89, v77, v24 quad_perm:[0,0,2,2] row_mask:0xf bank_mask:0xf
v_dot2c_f32_bf16_dpp v90, v76, v25 quad_perm:[0,0,2,2] row_mask:0xf bank_mask:0xf
v_dot2c_f32_bf16_dpp v91, v77, v25 quad_perm:[0,0,2,2] row_mask:0xf bank_mask:0xf
v_dot2c_f32_bf16_dpp v92, v76, v26 quad_perm:[0,0,2,2] row_mask:0xf bank_mask:0xf
v_dot2c_f32_bf16_dpp v93, v77, v26 quad_perm:[0,0,2,2] row_mask:0xf bank_mask:0xf
v_dot2c_f32_bf16_dpp v94, v76, v28 quad_perm:[1,1,3,3] row_mask:0xf bank_mask:0xf
v_dot2c_f32_bf16_dpp v95, v77, v28 quad_perm:[1,1,3,3] row_mask:0xf bank_mask:0xf
v_dot2c_f32_bf16_dpp v96, v76, v29 quad_perm:[1,1,3,3] row_mask:0xf bank_mask:0xf
v_dot2c_f32_bf16_dpp v97, v77, v29 quad_perm:[1,1,3,3] row_mask:0xf bank_mask:0xf
v_dot2c_f32_bf16_dpp v98, v76, v30 quad_perm:[1,1,3,3] row_mask:0xf bank_mask:0xf
v_dot2c_f32_bf16_dpp v99, v77, v30 quad_perm:[1,1,3,3] row_mask:0xf bank_mask:0xf
v_dot2c_f32_bf16_dpp v88, v78, v32 quad_perm:[0,0,2,2] row_mask:0xf bank_mask:0xf
v_dot2c_f32_bf16_dpp v89, v79, v32 quad_perm:[0,0,2,2] row_mask:0xf bank_mask:0xf
v_dot2c_f32_bf16_dpp v90, v78, v33 quad_perm:[0,0,2,2] row_mask:0xf bank_mask:0xf
v_dot2c_f32_bf16_dpp v91, v79, v33 quad_perm:[0,0,2,2] row_mask:0xf bank_mask:0xf
v_dot2c_f32_bf16_dpp v92, v78, v34 quad_perm:[0,0,2,2] row_mask:0xf bank_mask:0xf
v_dot2c_f32_bf16_dpp v93, v79, v34 quad_perm:[0,0,2,2] row_mask:0xf bank_mask:0xf
v_dot2c_f32_bf16_dpp v94, v78, v36 quad_perm:[1,1,3,3] row_mask:0xf bank_mask:0xf
v_dot2c_f32_bf16_dpp v95, v79, v36 quad_perm:[1,1,3,3] row_mask:0xf bank_mask:0xf
v_dot2c_f32_bf16_dpp v96, v78, v37 quad_perm:[1,1,3,3] row_mask:0xf bank_mask:0xf
v_dot2c_f32_bf16_dpp v97, v79, v37 quad_perm:[1,1,3,3] row_mask:0xf bank_mask:0xf
v_dot2c_f32_bf16_dpp v98, v78, v38 quad_perm:[1,1,3,3] row_mask:0xf bank_mask:0xf
v_dot2c_f32_bf16_dpp v99, v79, v38 quad_perm:[1,1,3,3] row_mask:0xf bank_mask:0xf
v_dot2c_f32_bf16_dpp v88, v80, v40 quad_perm:[0,0,2,2] row_mask:0xf bank_mask:0xf
v_dot2c_f32_bf16_dpp v89, v81, v40 quad_perm:[0,0,2,2] row_mask:0xf bank_mask:0xf
v_dot2c_f32_bf16_dpp v90, v80, v41 quad_perm:[0,0,2,2] row_mask:0xf bank_mask:0xf
v_dot2c_f32_bf16_dpp v91, v81, v41 quad_perm:[0,0,2,2] row_mask:0xf bank_mask:0xf
v_dot2c_f32_bf16_dpp v92, v80, v42 quad_perm:[0,0,2,2] row_mask:0xf bank_mask:0xf
v_dot2c_f32_bf16_dpp v93, v81, v42 quad_perm:[0,0,2,2] row_mask:0xf bank_mask:0xf
v_dot2c_f32_bf16_dpp v94, v80, v44 quad_perm:[1,1,3,3] row_mask:0xf bank_mask:0xf
v_dot2c_f32_bf16_dpp v95, v81, v44 quad_perm:[1,1,3,3] row_mask:0xf bank_mask:0xf
v_dot2c_f32_bf16_dpp v96, v80, v45 quad_perm:[1,1,3,3] row_mask:0xf bank_mask:0xf
v_dot2c_f32_bf16_dpp v97, v81, v45 quad_perm:[1,1,3,3] row_mask:0xf bank_mask:0xf
v_dot2c_f32_bf16_dpp v98, v80, v46 quad_perm:[1,1,3,3] row_mask:0xf bank_mask:0xf
v_dot2c_f32_bf16_dpp v99, v81, v46 quad_perm:[1,1,3,3] row_mask:0xf bank_mask:0xf
v_dot2c_f32_bf16_dpp v88, v82, v48 quad_perm:[0,0,2,2] row_mask:0xf bank_mask:0xf
v_dot2c_f32_bf16_dpp v89, v83, v48 quad_perm:[0,0,2,2] row_mask:0xf bank_mask:0xf
v_dot2c_f32_bf16_dpp v90, v82, v49 quad_perm:[0,0,2,2] row_mask:0xf bank_mask:0xf
v_dot2c_f32_bf16_dpp v91, v83, v49 quad_perm:[0,0,2,2] row_mask:0xf bank_mask:0xf
v_dot2c_f32_bf16_dpp v92, v82, v50 quad_perm:[0,0,2,2] row_mask:0xf bank_mask:0xf
v_dot2c_f32_bf16_dpp v93, v83, v50 quad_perm:[0,0,2,2] row_mask:0xf bank_mask:0xf
v_dot2c_f32_bf16_dpp v94, v82, v52 quad_perm:[1,1,3,3] row_mask:0xf bank_mask:0xf
v_dot2c_f32_bf16_dpp v95, v83, v52 quad_perm:[1,1,3,3] row_mask:0xf bank_mask:0xf
v_dot2c_f32_bf16_dpp v96, v82, v53 quad_perm:[1,1,3,3] row_mask:0xf bank_mask:0xf
v_dot2c_f32_bf16_dpp v97, v83, v53 quad_perm:[1,1,3,3] row_mask:0xf bank_mask:0xf
v_dot2c_f32_bf16_dpp v98, v82, v54 quad_perm:[1,1,3,3] row_mask:0xf bank_mask:0xf
v_dot2c_f32_bf16_dpp v99, v83, v54 quad_perm:[1,1,3,3] row_mask:0xf bank_mask:0xf
v_dot2c_f32_bf16_dpp v88, v84, v56 quad_perm:[0,0,2,2] row_mask:0xf bank_mask:0xf
v_dot2c_f32_bf16_dpp v89, v85, v56 quad_perm:[0,0,2,2] row_mask:0xf bank_mask:0xf
v_dot2c_f32_bf16_dpp v90, v84, v57 quad_perm:[0,0,2,2] row_mask:0xf bank_mask:0xf
v_dot2c_f32_bf16_dpp v91, v85, v57 quad_perm:[0,0,2,2] row_mask:0xf bank_mask:0xf
v_dot2c_f32_bf16_dpp v92, v84, v58 quad_perm:[0,0,2,2] row_mask:0xf bank_mask:0xf
v_dot2c_f32_bf16_dpp v93, v85, v58 quad_perm:[0,0,2,2] row_mask:0xf bank_mask:0xf
v_dot2c_f32_bf16_dpp v94, v84, v60 quad_perm:[1,1,3,3] row_mask:0xf bank_mask:0xf
v_dot2c_f32_bf16_dpp v95, v85, v60 quad_perm:[1,1,3,3] row_mask:0xf bank_mask:0xf
v_dot2c_f32_bf16_dpp v96, v84, v61 quad_perm:[1,1,3,3] row_mask:0xf bank_mask:0xf
v_dot2c_f32_bf16_dpp v97, v85, v61 quad_perm:[1,1,3,3] row_mask:0xf bank_mask:0xf
v_dot2c_f32_bf16_dpp v98, v84, v62 quad_perm:[1,1,3,3] row_mask:0xf bank_mask:0xf
v_dot2c_f32_bf16_dpp v99, v85, v62 quad_perm:[1,1,3,3] row_mask:0xf bank_mask:0xf
v_dot2c_f32_bf16_dpp v88, v86, v64 quad_perm:[0,0,2,2] row_mask:0xf bank_mask:0xf
v_dot2c_f32_bf16_dpp v89, v87, v64 quad_perm:[0,0,2,2] row_mask:0xf bank_mask:0xf
v_dot2c_f32_bf16_dpp v90, v86, v65 quad_perm:[0,0,2,2] row_mask:0xf bank_mask:0xf
v_dot2c_f32_bf16_dpp v91, v87, v65 quad_perm:[0,0,2,2] row_mask:0xf bank_mask:0xf
v_dot2c_f32_bf16_dpp v92, v86, v66 quad_perm:[0,0,2,2] row_mask:0xf bank_mask:0xf
v_dot2c_f32_bf16_dpp v93, v87, v66 quad_perm:[0,0,2,2] row_mask:0xf bank_mask:0xf
v_dot2c_f32_bf16_dpp v94, v86, v68 quad_perm:[1,1,3,3] row_mask:0xf bank_mask:0xf
v_dot2c_f32_bf16_dpp v95, v87, v68 quad_perm:[1,1,3,3] row_mask:0xf bank_mask:0xf
v_dot2c_f32_bf16_dpp v96, v86, v69 quad_perm:[1,1,3,3] row_mask:0xf bank_mask:0xf
v_dot2c_f32_bf16_dpp v97, v87, v69 quad_perm:[1,1,3,3] row_mask:0xf bank_mask:0xf
v_dot2c_f32_bf16_dpp v98, v86, v70 quad_perm:[1,1,3,3] row_mask:0xf bank_mask:0xf
v_dot2c_f32_bf16_dpp v99, v87, v70 quad_perm:[1,1,3,3] row_mask:0xf bank_mask:0xf
v_add_f32 v101, v73, v75
v_add_f32 v101, v101, v77
v_add_f32 v101, v101, v79
v_add_f32 v101, v101, v81
v_add_f32 v101, v101, v83
v_add_f32 v101, v101, v85
v_add_f32 v101, v101, v87
v_add_f32 v88, v88, v94
v_add_f32 v89, v89, v95
v_add_f32 v90, v90, v96
v_add_f32 v91, v91, v97
v_add_f32 v92, v92, v98
v_add_f32 v93, v93, v99
v_add_f32_dpp v101, v101, v101 quad_perm:[1,0,3,2] row_mask:0xf bank_mask:0xf
v_permlane32_swap_b32 v88, v89
v_permlane32_swap_b32 v90, v91
v_permlane32_swap_b32 v92, v93
v_mov_b32 v102, v101
v_add_f32 v88, v88, v89
v_add_f32 v90, v90, v91
v_add_f32 v92, v92, v93
v_permlane32_swap_b32 v101, v102
ds_write_b32 v4, v88 offset:0
ds_write_b32 v7, v90 offset:8
ds_write_b32 v4, v92 offset:64
v_add_f32 v101, v101, v102
ds_write_b64 v6, v[100:101] offset:6144
s_waitcnt lgkmcnt(0)
s_barrier
s_cmp_lt_u32 s24, 4
s_cbranch_scc1 F_st3
s_cmp_eq_u32 s24, 7
s_cbranch_scc1 F_aux
s_lshl_b32 s25, s24, 6
s_sub_u32 s25, s25, 256
v_add_u32 v3, s25, v0
v_mul_u32_u24 v4, 1366, v3
v_lshrrev_b32 v4, 16, v4
v_lshlrev_b32 v4, 6, v4
v_lshlrev_b32 v5, 2, v3
ds_read_b128 v[72:75], v4 offset:6144
ds_read_b128 v[76:79], v4 offset:6160
ds_read_b128 v[80:83], v4 offset:6176
ds_read_b128 v[84:87], v4 offset:6192
ds_read_b32 v8, v5 offset:0
ds_read_b32 v9, v5 offset:768
ds_read_b32 v10, v5 offset:1536
ds_read_b32 v11, v5 offset:2304
ds_read_b32 v12, v5 offset:3072
ds_read_b32 v13, v5 offset:3840
ds_read_b32 v14, v5 offset:4608
ds_read_b32 v15, v5 offset:5376
s_waitcnt lgkmcnt(8)
v_max3_f32 v100, v72, v74, v76
v_max3_f32 v101, v78, v80, v82
v_max3_f32 v100, v100, v84, v86
v_max_f32 v100, v100, v101
v_sub_f32 v72, v72, v100
v_sub_f32 v74, v74, v100
v_sub_f32 v76, v76, v100
v_sub_f32 v78, v78, v100
v_sub_f32 v80, v80, v100
v_sub_f32 v82, v82, v100
v_sub_f32 v84, v84, v100
v_sub_f32 v86, v86, v100
v_exp_f32 v72, v72
v_exp_f32 v74, v74
v_exp_f32 v76, v76
v_exp_f32 v78, v78
v_exp_f32 v80, v80
v_exp_f32 v82, v82
v_exp_f32 v84, v84
v_exp_f32 v86, v86
v_mul_f32 v101, v72, v73
v_fmac_f32 v101, v74, v75
v_fmac_f32 v101, v76, v77
v_fmac_f32 v101, v78, v79
v_fmac_f32 v101, v80, v81
v_fmac_f32 v101, v82, v83
v_fmac_f32 v101, v84, v85
v_fmac_f32 v101, v86, v87
v_rcp_f32 v101, v101
v_lshlrev_b32 v5, 1, v3
s_waitcnt lgkmcnt(0)
v_mul_f32 v102, v72, v8
v_mul_f32 v103, v74, v9
v_fmac_f32 v102, v76, v10
v_fmac_f32 v103, v78, v11
v_fmac_f32 v102, v80, v12
v_fmac_f32 v103, v82, v13
v_fmac_f32 v102, v84, v14
v_fmac_f32 v103, v86, v15
v_add_f32 v102, v102, v103
v_mul_f32 v102, v102, v101
v_cvt_pk_bf16_f32 v102, v102, v102
ds_write_b16 v5, v102 offset:6400
s_waitcnt lgkmcnt(0)
s_barrier
s_endpgm
F_aux:
s_cmp_eq_u32 s5, 0
s_cbranch_scc0 F_end
v_mov_b32 v3, s7
v_mov_b32 v4, 671744
s_mov_b64 exec, 1
buffer_store_dword v3, v4, s[20:23], 0 offen sc1
s_mov_b64 exec, -1
F_end:
s_barrier
s_endpgm
F_st3:
v_lshlrev_b32 v3, 4, v2
v_lshlrev_b32 v88, 16, v240
v_and_b32 v89, 0xffff0000, v240
v_lshlrev_b32 v90, 16, v241
v_and_b32 v91, 0xffff0000, v241
v_lshlrev_b32 v92, 16, v242
v_and_b32 v93, 0xffff0000, v242
v_lshlrev_b32 v94, 16, v243
v_and_b32 v95, 0xffff0000, v243
v_lshlrev_b32 v96, 16, v244
v_and_b32 v97, 0xffff0000, v244
v_lshlrev_b32 v98, 16, v245
v_and_b32 v99, 0xffff0000, v245
v_and_b32 v4, 15, v0
v_cmp_eq_u32 s[32:33], 0, v4
s_barrier
ds_read_b128 v[8:11], v3 offset:6400
ds_read_b128 v[12:15], v3 offset:6464
ds_read_b128 v[16:19], v3 offset:6528
ds_read_b128 v[20:23], v3 offset:6592
ds_read_b128 v[24:27], v3 offset:6656
ds_read_b128 v[28:31], v3 offset:6720
s_waitcnt lgkmcnt(5)
v_mfma_f32_16x16x32_bf16 v[104:107], v[144:147], v[8:11], v[88:91]
v_mfma_f32_16x16x32_bf16 v[108:111], v[168:171], v[8:11], v[92:95]
v_mfma_f32_16x16x32_bf16 v[112:115], v[192:195], v[8:11], v[96:99]
s_waitcnt lgkmcnt(4)
v_mfma_f32_16x16x32_bf16 v[104:107], v[148:151], v[12:15], v[104:107]
v_mfma_f32_16x16x32_bf16 v[108:111], v[172:175], v[12:15], v[108:111]
v_mfma_f32_16x16x32_bf16 v[112:115], v[196:199], v[12:15], v[112:115]
s_waitcnt lgkmcnt(3)
v_mfma_f32_16x16x32_bf16 v[104:107], v[152:155], v[16:19], v[104:107]
v_mfma_f32_16x16x32_bf16 v[108:111], v[176:179], v[16:19], v[108:111]
v_mfma_f32_16x16x32_bf16 v[112:115], v[200:203], v[16:19], v[112:115]
s_waitcnt lgkmcnt(2)
v_mfma_f32_16x16x32_bf16 v[104:107], v[156:159], v[20:23], v[104:107]
v_mfma_f32_16x16x32_bf16 v[108:111], v[180:183], v[20:23], v[108:111]
v_mfma_f32_16x16x32_bf16 v[112:115], v[204:207], v[20:23], v[112:115]
s_waitcnt lgkmcnt(1)
v_mfma_f32_16x16x32_bf16 v[104:107], v[160:163], v[24:27], v[104:107]
v_mfma_f32_16x16x32_bf16 v[108:111], v[184:187], v[24:27], v[108:111]
v_mfma_f32_16x16x32_bf16 v[112:115], v[208:211], v[24:27], v[112:115]
s_waitcnt lgkmcnt(0)
v_mfma_f32_16x16x32_bf16 v[104:107], v[164:167], v[28:31], v[104:107]
v_mfma_f32_16x16x32_bf16 v[108:111], v[188:191], v[28:31], v[108:111]
v_mfma_f32_16x16x32_bf16 v[112:115], v[212:215], v[28:31], v[112:115]
s_nop 5
v_cvt_pk_bf16_f32 v116, v104, v105
v_cvt_pk_bf16_f32 v117, v106, v107
v_cvt_pk_bf16_f32 v118, v108, v109
v_cvt_pk_bf16_f32 v119, v110, v111
v_cvt_pk_bf16_f32 v120, v112, v113
v_cvt_pk_bf16_f32 v121, v114, v115
s_mov_b64 exec, s[32:33]
buffer_store_dwordx2 v[116:117], v247, s[16:19], s8 offen offset:0
buffer_store_dwordx2 v[118:119], v247, s[16:19], s8 offen offset:32
buffer_store_dwordx2 v[120:121], v247, s[16:19], s8 offen offset:64
s_endpgm
PR_compA:
s_mov_b32 s20, s70
s_mov_b32 s21, s71
s_mov_b32 s22, 402653184
s_mov_b32 s23, 0x20000
v_and_b32 v232, 15, v246
v_lshrrev_b32 v233, 4, v246
v_bfe_u32 v236, v246, 2, 2
v_lshl_add_u32 v236, v233, 3, v236
v_and_b32 v237, 3, v246
v_lshlrev_b32 v237, 3, v237
v_mul_u32_u24 v236, 96, v236
v_add_u32 v236, v236, v237
v_add_u32 v236, 76032, v236
v_and_b32 v237, 7, v246
v_xor_b32 v234, v233, v237
v_lshlrev_b32 v234, 4, v234
v_lshl_add_u32 v234, v237, 7, v234
v_bfe_u32 v237, v246, 3, 1
v_lshl_add_u32 v234, v237, 10, v234
v_add_u32 v234, 112896, v234
v_xor_b32 v242, 64, v234
v_mul_u32_u24 v235, 96, v232
v_lshl_add_u32 v235, v233, 3, v235
v_add_u32 v235, 119040, v235
v_lshrrev_b32 v239, 1, v233
v_lshlrev_b32 v239, 9, v239
v_lshl_add_u32 v239, v232, 4, v239
v_and_b32 v240, 1, v233
v_lshl_add_u32 v239, v240, 11, v239
s_lshr_b32 s44, s36, 1
s_lshl_b32 s44, s44, 2
s_add_u32 s44, s44, s37
s_lshl_b32 s44, s44, 12
s_and_b32 s45, s36, 1
s_lshl_b32 s45, s45, 8
s_add_u32 s44, s44, s45
s_and_b32 s45, s2, 7
s_lshl_b32 s45, s45, 15
s_add_u32 s44, s44, s45
s_add_u32 s45, s44, 262144
s_mov_b32 s46, 0x3e553b95
s_mov_b32 s47, 0x3dd53b95
v_mov_b32 v241, 0x3f803f80
v_mov_b32 v223, 0
s_waitcnt lgkmcnt(0)
s_mul_i32 s7, s7, 1664525
s_add_u32 s7, s7, 1013904223
s_or_b32 s7, s7, 1
s_mov_b64 exec, 0
s_branch WP_acomp1_0
W_retA:
s_mov_b64 exec, -1
v_lshlrev_b32 v237, 2, v246
v_and_b32 v237, 31, v237
v_add_u32 v237, 158816, v237
FW26:
ds_read_b32 v238, v237
s_waitcnt lgkmcnt(0)
v_cmp_eq_u32 vcc, 0, v238
s_and_b32 s6, vcc_lo, 255
s_cmp_eq_u32 s6, 255
s_cbranch_scc0 FW26
WP_acomp1_0:
s_cbranch_execz WP_acomp1_1
ds_read_b128 v[144:147], v234 offset:0
ds_read_b64_tr_b16 v[0:1], v236 offset:0
ds_read_b64_tr_b16 v[2:3], v236 offset:384
ds_read_b64_tr_b16 v[4:5], v236 offset:32
ds_read_b64_tr_b16 v[6:7], v236 offset:416
ds_read_b64_tr_b16 v[8:9], v236 offset:64
ds_read_b64_tr_b16 v[10:11], v236 offset:448
ds_read_b128 v[148:151], v242 offset:0
ds_read_b64_tr_b16 v[12:13], v236 offset:3072
ds_read_b64_tr_b16 v[14:15], v236 offset:3456
ds_read_b64_tr_b16 v[16:17], v236 offset:3104
ds_read_b64_tr_b16 v[18:19], v236 offset:3488
ds_read_b64_tr_b16 v[20:21], v236 offset:3136
ds_read_b64_tr_b16 v[22:23], v236 offset:3520
ds_read_b128 v[152:155], v234 offset:2048
ds_read_b64_tr_b16 v[24:25], v236 offset:6144
ds_read_b64_tr_b16 v[26:27], v236 offset:6528
ds_read_b64_tr_b16 v[28:29], v236 offset:6176
ds_read_b64_tr_b16 v[30:31], v236 offset:6560
ds_read_b64_tr_b16 v[32:33], v236 offset:6208
ds_read_b64_tr_b16 v[34:35], v236 offset:6592
WP_acomp1_1:
s_cbranch_execz WP_acomp1_2
s_waitcnt lgkmcnt(14)
v_mfma_f32_16x16x32_bf16 v[188:191], v[0:3], v[144:147], 0
v_mfma_f32_16x16x32_bf16 v[192:195], v[4:7], v[144:147], 0
v_mfma_f32_16x16x32_bf16 v[196:199], v[8:11], v[144:147], 0
ds_read_b128 v[156:159], v242 offset:2048
ds_read_b64_tr_b16 v[36:37], v236 offset:9216
ds_read_b64_tr_b16 v[38:39], v236 offset:9600
ds_read_b64_tr_b16 v[40:41], v236 offset:9248
ds_read_b64_tr_b16 v[42:43], v236 offset:9632
ds_read_b64_tr_b16 v[44:45], v236 offset:9280
ds_read_b64_tr_b16 v[46:47], v236 offset:9664
s_waitcnt lgkmcnt(14)
v_mfma_f32_16x16x32_bf16 v[188:191], v[12:15], v[148:151], v[188:191]
v_mfma_f32_16x16x32_bf16 v[192:195], v[16:19], v[148:151], v[192:195]
v_mfma_f32_16x16x32_bf16 v[196:199], v[20:23], v[148:151], v[196:199]
ds_read_b128 v[160:163], v234 offset:4096
ds_read_b64_tr_b16 v[48:49], v236 offset:12288
ds_read_b64_tr_b16 v[50:51], v236 offset:12672
ds_read_b64_tr_b16 v[52:53], v236 offset:12320
ds_read_b64_tr_b16 v[54:55], v236 offset:12704
ds_read_b64_tr_b16 v[56:57], v236 offset:12352
ds_read_b64_tr_b16 v[58:59], v236 offset:12736
WP_acomp1_2:
s_cbranch_execz WP_acomp1_3
s_waitcnt lgkmcnt(14)
v_mfma_f32_16x16x32_bf16 v[188:191], v[24:27], v[152:155], v[188:191]
v_mfma_f32_16x16x32_bf16 v[192:195], v[28:31], v[152:155], v[192:195]
v_mfma_f32_16x16x32_bf16 v[196:199], v[32:35], v[152:155], v[196:199]
ds_read_b128 v[164:167], v242 offset:4096
ds_read_b64_tr_b16 v[60:61], v236 offset:15360
ds_read_b64_tr_b16 v[62:63], v236 offset:15744
ds_read_b64_tr_b16 v[64:65], v236 offset:15392
ds_read_b64_tr_b16 v[66:67], v236 offset:15776
ds_read_b64_tr_b16 v[68:69], v236 offset:15424
ds_read_b64_tr_b16 v[70:71], v236 offset:15808
s_waitcnt lgkmcnt(14)
v_mfma_f32_16x16x32_bf16 v[188:191], v[36:39], v[156:159], v[188:191]
v_mfma_f32_16x16x32_bf16 v[192:195], v[40:43], v[156:159], v[192:195]
v_mfma_f32_16x16x32_bf16 v[196:199], v[44:47], v[156:159], v[196:199]
ds_read_b64 v[168:169], v235 offset:0
ds_read_b64 v[170:171], v235 offset:32
ds_read_b64 v[172:173], v235 offset:64
ds_read_b64 v[174:175], v235 offset:1536
ds_read_b64 v[176:177], v235 offset:1568
ds_read_b64 v[178:179], v235 offset:1600
ds_read_b64 v[180:181], v235 offset:3072
WP_acomp1_3:
s_cbranch_execz WP_acomp1_4
s_waitcnt lgkmcnt(14)
v_mfma_f32_16x16x32_bf16 v[188:191], v[48:51], v[160:163], v[188:191]
v_mfma_f32_16x16x32_bf16 v[192:195], v[52:55], v[160:163], v[192:195]
v_mfma_f32_16x16x32_bf16 v[196:199], v[56:59], v[160:163], v[196:199]
ds_read_b64 v[182:183], v235 offset:3104
ds_read_b64 v[184:185], v235 offset:3136
ds_read_b64_tr_b16 v[72:73], v236 offset:18432
ds_read_b64_tr_b16 v[74:75], v236 offset:18816
ds_read_b64_tr_b16 v[76:77], v236 offset:18464
ds_read_b64_tr_b16 v[78:79], v236 offset:18848
ds_read_b64_tr_b16 v[80:81], v236 offset:18496
s_waitcnt lgkmcnt(14)
v_mfma_f32_16x16x32_bf16 v[188:191], v[60:63], v[164:167], v[188:191]
v_mfma_f32_16x16x32_bf16 v[192:195], v[64:67], v[164:167], v[192:195]
v_mfma_f32_16x16x32_bf16 v[196:199], v[68:71], v[164:167], v[196:199]
ds_read_b64_tr_b16 v[82:83], v236 offset:18880
ds_read_b64_tr_b16 v[84:85], v236 offset:21504
ds_read_b64_tr_b16 v[86:87], v236 offset:21888
ds_read_b64_tr_b16 v[88:89], v236 offset:21536
ds_read_b64_tr_b16 v[90:91], v236 offset:21920
ds_read_b64_tr_b16 v[92:93], v236 offset:21568
ds_read_b64_tr_b16 v[94:95], v236 offset:21952
ds_read_b64_tr_b16 v[96:97], v236 offset:24576
ds_read_b64_tr_b16 v[98:99], v236 offset:24960
ds_read_b64_tr_b16 v[100:101], v236 offset:24608
v_cvt_pk_bf16_f32 v212, v188, v189
v_cvt_pk_bf16_f32 v213, v190, v191
v_cvt_pk_bf16_f32 v214, v192, v193
v_cvt_pk_bf16_f32 v215, v194, v195
v_cvt_pk_bf16_f32 v216, v196, v197
v_cvt_pk_bf16_f32 v217, v198, v199
ds_read_b64_tr_b16 v[102:103], v236 offset:24992
WP_acomp1_4:
s_cbranch_execz WP_acomp1_5
ds_read_b64_tr_b16 v[104:105], v236 offset:24640
ds_read_b64_tr_b16 v[106:107], v236 offset:25024
s_waitcnt lgkmcnt(15)
v_mfma_f32_16x16x32_bf16 v[0:3], v[168:171], v[212:215], 0
v_mfma_f32_16x16x32_bf16 v[4:7], v[174:177], v[212:215], 0
v_mfma_f32_16x16x32_bf16 v[8:11], v[180:183], v[212:215], 0
v_mfma_f32_16x16x16_bf16 v[12:15], v[172:173], v[216:217], 0
v_mfma_f32_16x16x16_bf16 v[16:19], v[178:179], v[216:217], 0
v_mfma_f32_16x16x16_bf16 v[20:23], v[184:185], v[216:217], 0
ds_read_b64_tr_b16 v[108:109], v236 offset:27648
ds_read_b64_tr_b16 v[110:111], v236 offset:28032
ds_read_b64_tr_b16 v[112:113], v236 offset:27680
ds_read_b64_tr_b16 v[114:115], v236 offset:28064
ds_read_b64_tr_b16 v[116:117], v236 offset:27712
ds_read_b64_tr_b16 v[118:119], v236 offset:28096
s_waitcnt lgkmcnt(15)
v_mfma_f32_16x16x32_bf16 v[200:203], v[72:75], v[144:147], 0
v_mfma_f32_16x16x32_bf16 v[204:207], v[76:79], v[144:147], 0
v_mfma_f32_16x16x32_bf16 v[208:211], v[80:83], v[144:147], 0
ds_read_b64_tr_b16 v[120:121], v236 offset:30720
ds_read_b64_tr_b16 v[122:123], v236 offset:31104
ds_read_b64_tr_b16 v[124:125], v236 offset:30752
ds_read_b64_tr_b16 v[126:127], v236 offset:31136
ds_read_b64_tr_b16 v[128:129], v236 offset:30784
ds_read_b64_tr_b16 v[130:131], v236 offset:31168
WP_acomp1_5:
s_cbranch_execz WP_acomp1_6
s_waitcnt lgkmcnt(15)
v_mfma_f32_16x16x32_bf16 v[200:203], v[84:87], v[148:151], v[200:203]
v_mfma_f32_16x16x32_bf16 v[204:207], v[88:91], v[148:151], v[204:207]
v_mfma_f32_16x16x32_bf16 v[208:211], v[92:95], v[148:151], v[208:211]
ds_read_b64_tr_b16 v[132:133], v236 offset:33792
ds_read_b64_tr_b16 v[134:135], v236 offset:34176
ds_read_b64_tr_b16 v[136:137], v236 offset:33824
ds_read_b64_tr_b16 v[138:139], v236 offset:34208
ds_read_b64_tr_b16 v[140:141], v236 offset:33856
ds_read_b64_tr_b16 v[142:143], v236 offset:34240
s_waitcnt lgkmcnt(15)
v_mfma_f32_16x16x32_bf16 v[200:203], v[96:99], v[152:155], v[200:203]
v_mfma_f32_16x16x32_bf16 v[204:207], v[100:103], v[152:155], v[204:207]
v_mfma_f32_16x16x32_bf16 v[208:211], v[104:107], v[152:155], v[208:211]
v_add_f32 v0, v0, v12
v_add_f32 v1, v1, v13
v_add_f32 v2, v2, v14
v_add_f32 v3, v3, v15
v_mul_f32 v0, s46, v0
v_mul_f32 v1, s46, v1
v_mul_f32 v2, s46, v2
v_mul_f32 v3, s46, v3
s_waitcnt lgkmcnt(12)
v_mfma_f32_16x16x32_bf16 v[200:203], v[108:111], v[156:159], v[200:203]
v_mfma_f32_16x16x32_bf16 v[204:207], v[112:115], v[156:159], v[204:207]
v_mfma_f32_16x16x32_bf16 v[208:211], v[116:119], v[156:159], v[208:211]
v_add_f32 v4, v4, v16
v_add_f32 v5, v5, v17
v_add_f32 v6, v6, v18
v_add_f32 v7, v7, v19
v_mul_f32 v4, s46, v4
v_mul_f32 v5, s46, v5
v_mul_f32 v6, s46, v6
v_mul_f32 v7, s46, v7
WP_acomp1_6:
s_cbranch_execz WP_acomp1_7
s_waitcnt lgkmcnt(6)
v_mfma_f32_16x16x32_bf16 v[200:203], v[120:123], v[160:163], v[200:203]
v_mfma_f32_16x16x32_bf16 v[204:207], v[124:127], v[160:163], v[204:207]
v_mfma_f32_16x16x32_bf16 v[208:211], v[128:131], v[160:163], v[208:211]
v_add_f32 v8, v8, v20
v_add_f32 v9, v9, v21
v_add_f32 v10, v10, v22
v_add_f32 v11, v11, v23
v_mul_f32 v8, s46, v8
v_mul_f32 v9, s46, v9
v_mul_f32 v10, s46, v10
v_mul_f32 v11, s46, v11
s_waitcnt lgkmcnt(0)
v_mfma_f32_16x16x32_bf16 v[200:203], v[132:135], v[164:167], v[200:203]
v_mfma_f32_16x16x32_bf16 v[204:207], v[136:139], v[164:167], v[204:207]
v_mfma_f32_16x16x32_bf16 v[208:211], v[140:143], v[164:167], v[208:211]
s_nop 5
v_cvt_pk_bf16_f32 v200, v200, v201
v_cvt_pk_bf16_f32 v202, v202, v203
v_cvt_pk_bf16_f32 v204, v204, v205
v_cvt_pk_bf16_f32 v206, v206, v207
v_cvt_pk_bf16_f32 v208, v208, v209
v_cvt_pk_bf16_f32 v210, v210, v211
v_and_b32 v201, 0xffff0000, v200
v_lshlrev_b32 v200, 16, v200
v_and_b32 v203, 0xffff0000, v202
v_lshlrev_b32 v202, 16, v202
v_fma_f32 v0, v200, s47, v0
v_fma_f32 v1, v201, s47, v1
v_fma_f32 v2, v202, s47, v2
v_fma_f32 v3, v203, s47, v3
v_cvt_pk_bf16_f32 v220, v0, v1
v_cvt_pk_bf16_f32 v221, v2, v3
v_and_b32 v205, 0xffff0000, v204
v_lshlrev_b32 v204, 16, v204
v_and_b32 v207, 0xffff0000, v206
v_lshlrev_b32 v206, 16, v206
v_fma_f32 v4, v204, s47, v4
WP_acomp1_7:
s_cbranch_execz W_retA
v_fma_f32 v5, v205, s47, v5
v_fma_f32 v6, v206, s47, v6
v_fma_f32 v7, v207, s47, v7
v_cvt_pk_bf16_f32 v222, v4, v5
v_cvt_pk_bf16_f32 v224, v6, v7
v_and_b32 v209, 0xffff0000, v208
v_lshlrev_b32 v208, 16, v208
v_and_b32 v211, 0xffff0000, v210
v_lshlrev_b32 v210, 16, v210
v_fma_f32 v8, v208, s47, v8
v_fma_f32 v9, v209, s47, v9
v_fma_f32 v10, v210, s47, v10
v_fma_f32 v11, v211, s47, v11
v_cvt_pk_bf16_f32 v225, v8, v9
v_cvt_pk_bf16_f32 v226, v10, v11
v_dot2c_f32_bf16 v223, v220, v241
v_dot2c_f32_bf16 v223, v221, v241
v_dot2c_f32_bf16 v223, v222, v241
v_dot2c_f32_bf16 v223, v224, v241
v_dot2c_f32_bf16 v223, v225, v241
v_dot2c_f32_bf16 v223, v226, v241
s_nop 2
v_add_u32 v227, s7, v223
buffer_store_dwordx4 v[220:223], v239, s[20:23], s44 offen
buffer_store_dwordx4 v[224:227], v239, s[20:23], s44 offen offset:1024
buffer_store_dwordx4 v[220:223], v239, s[20:23], s45 offen sc1
buffer_store_dwordx4 v[224:227], v239, s[20:23], s45 offen offset:1024 sc1
s_barrier
s_lshl_b32 s6, s24, 2
s_add_u32 s6, s6, 158752
v_mov_b32 v237, s6
v_mov_b32 v238, 1
ds_write_b32 v237, v238
s_branch C_pro2
PR_issueV:
s_sub_u32 s12, s2, 128
s_mul_i32 s41, s12, 86
s_lshr_b32 s41, s41, 8
s_mul_i32 s42, s41, 3
s_sub_u32 s42, s12, s42
s_mul_i32 s43, s41, 18432
s_lshl_b32 s42, s42, 5
s_add_u32 s43, s43, s42
s_sub_u32 s42, s12, 12
s_lshl_b32 s42, s42, 5
s_cmp_lt_u32 s12, 12
s_cselect_b32 s16, s60, s62
s_cselect_b32 s17, s61, s63
s_mov_b32 s18, 73728
s_mov_b32 s19, 0x20000
s_cselect_b32 s43, s43, s42
s_movk_i32 s44, 96
s_cselect_b32 s42, s44, 384
v_lshrrev_b32 v216, 1, v246
v_mul_lo_u32 v216, v216, s42
v_and_b32 v217, 1, v246
v_lshl_add_u32 v216, v217, 4, v216
s_lshl_b32 s42, s42, 5
s_mov_b32 m0, 150528
s_nop 0
buffer_load_dwordx4 v216, s[16:19], s43 offen lds
s_add_u32 s43, s43, s42
s_mov_b32 m0, 151552
s_nop 0
buffer_load_dwordx4 v216, s[16:19], s43 offen lds
s_add_u32 s43, s43, s42
s_mov_b32 m0, 152576
s_nop 0
buffer_load_dwordx4 v216, s[16:19], s43 offen lds
s_add_u32 s43, s43, s42
s_mov_b32 m0, 153600
s_nop 0
buffer_load_dwordx4 v216, s[16:19], s43 offen lds
s_add_u32 s43, s43, s42
s_mov_b32 m0, 154624
s_nop 0
buffer_load_dwordx4 v216, s[16:19], s43 offen lds
s_add_u32 s43, s43, s42
s_mov_b32 m0, 155648
s_nop 0
buffer_load_dwordx4 v216, s[16:19], s43 offen lds
s_barrier
s_mov_b32 s20, s70
s_mov_b32 s21, s71
s_mov_b32 s22, 402653184
s_mov_b32 s23, 0x20000
s_waitcnt vmcnt(6)
s_lshl_b32 s6, s24, 2
s_add_u32 s6, s6, 158752
v_mov_b32 v250, s6
v_mov_b32 v251, 1
ds_write_b32 v250, v251
s_waitcnt lgkmcnt(0)
s_mul_i32 s7, s7, 1664525
s_add_u32 s7, s7, 1013904223
s_or_b32 s7, s7, 1
s_waitcnt vmcnt(0)
v_lshrrev_b32 v216, 4, v246
v_and_b32 v217, 1, v216
v_lshlrev_b32 v217, 4, v217
v_lshrrev_b32 v218, 1, v216
v_lshl_add_u32 v217, v218, 2, v217
v_lshlrev_b32 v218, 3, v216
s_cmp_lt_u32 s12, 12
s_cselect_b64 vcc, -1, 0
s_movk_i32 s44, 256
s_cselect_b32 s42, s44, 128
v_cndmask_b32 v217, v218, v217, vcc
v_bfe_u32 v218, v246, 2, 2
v_add_u32 v217, v217, v218
v_and_b32 v218, 3, v246
v_lshlrev_b32 v218, 3, v218
v_lshl_add_u32 v217, v217, 5, v218
v_add_u32 v217, 150528, v217
v_add_u32 v218, s42, v217
ds_read_b64_tr_b16 v[184:185], v217 offset:0
ds_read_b64_tr_b16 v[186:187], v218 offset:0
ds_read_b64_tr_b16 v[188:189], v217 offset:1024
ds_read_b64_tr_b16 v[190:191], v218 offset:1024
ds_read_b64_tr_b16 v[192:193], v217 offset:2048
ds_read_b64_tr_b16 v[194:195], v218 offset:2048
ds_read_b64_tr_b16 v[196:197], v217 offset:3072
ds_read_b64_tr_b16 v[198:199], v218 offset:3072
ds_read_b64_tr_b16 v[200:201], v217 offset:4096
ds_read_b64_tr_b16 v[202:203], v218 offset:4096
ds_read_b64_tr_b16 v[204:205], v217 offset:5120
ds_read_b64_tr_b16 v[206:207], v218 offset:5120
v_lshrrev_b32 v219, 3, v246
v_mul_u32_u24 v219, 384, v219
v_and_b32 v220, 7, v246
v_lshl_add_u32 v219, v220, 4, v219
s_mul_i32 s44, s12, 6144
s_add_u32 s44, s44, 524288
v_mov_b32 v208, 0x3f803f80
v_mov_b32 v209, 0x3f803f80
v_mov_b32 v210, 0x3f803f80
v_mov_b32 v211, 0x3f803f80
s_mov_b32 s46, 0x3baaaaab
s_waitcnt lgkmcnt(0)
s_cmp_lt_u32 s12, 12
s_cbranch_scc0 PR_store
v_mfma_f32_16x16x32_bf16 v[212:215], v[208:211], v[184:187], 0
v_mfma_f32_16x16x32_bf16 v[212:215], v[208:211], v[188:191], v[212:215]
v_mfma_f32_16x16x32_bf16 v[212:215], v[208:211], v[192:195], v[212:215]
v_mfma_f32_16x16x32_bf16 v[212:215], v[208:211], v[196:199], v[212:215]
v_mfma_f32_16x16x32_bf16 v[212:215], v[208:211], v[200:203], v[212:215]
v_mfma_f32_16x16x32_bf16 v[212:215], v[208:211], v[204:207], v[212:215]
s_nop 7
v_mul_f32 v212, s46, v212
v_lshlrev_b32 v213, 16, v184
v_and_b32 v214, 0xffff0000, v184
v_sub_f32 v213, v213, v212
v_sub_f32 v214, v214, v212
v_cvt_pk_bf16_f32 v184, v213, v214
v_lshlrev_b32 v213, 16, v185
v_and_b32 v214, 0xffff0000, v185
v_sub_f32 v213, v213, v212
v_sub_f32 v214, v214, v212
v_cvt_pk_bf16_f32 v185, v213, v214
v_lshlrev_b32 v213, 16, v186
v_and_b32 v214, 0xffff0000, v186
v_sub_f32 v213, v213, v212
v_sub_f32 v214, v214, v212
v_cvt_pk_bf16_f32 v186, v213, v214
v_lshlrev_b32 v213, 16, v187
v_and_b32 v214, 0xffff0000, v187
v_sub_f32 v213, v213, v212
v_sub_f32 v214, v214, v212
v_cvt_pk_bf16_f32 v187, v213, v214
v_lshlrev_b32 v213, 16, v188
v_and_b32 v214, 0xffff0000, v188
v_sub_f32 v213, v213, v212
v_sub_f32 v214, v214, v212
v_cvt_pk_bf16_f32 v188, v213, v214
v_lshlrev_b32 v213, 16, v189
v_and_b32 v214, 0xffff0000, v189
v_sub_f32 v213, v213, v212
v_sub_f32 v214, v214, v212
v_cvt_pk_bf16_f32 v189, v213, v214
v_lshlrev_b32 v213, 16, v190
v_and_b32 v214, 0xffff0000, v190
v_sub_f32 v213, v213, v212
v_sub_f32 v214, v214, v212
v_cvt_pk_bf16_f32 v190, v213, v214
v_lshlrev_b32 v213, 16, v191
v_and_b32 v214, 0xffff0000, v191
v_sub_f32 v213, v213, v212
v_sub_f32 v214, v214, v212
v_cvt_pk_bf16_f32 v191, v213, v214
v_lshlrev_b32 v213, 16, v192
v_and_b32 v214, 0xffff0000, v192
v_sub_f32 v213, v213, v212
v_sub_f32 v214, v214, v212
v_cvt_pk_bf16_f32 v192, v213, v214
v_lshlrev_b32 v213, 16, v193
v_and_b32 v214, 0xffff0000, v193
v_sub_f32 v213, v213, v212
v_sub_f32 v214, v214, v212
v_cvt_pk_bf16_f32 v193, v213, v214
v_lshlrev_b32 v213, 16, v194
v_and_b32 v214, 0xffff0000, v194
v_sub_f32 v213, v213, v212
v_sub_f32 v214, v214, v212
v_cvt_pk_bf16_f32 v194, v213, v214
v_lshlrev_b32 v213, 16, v195
v_and_b32 v214, 0xffff0000, v195
v_sub_f32 v213, v213, v212
v_sub_f32 v214, v214, v212
v_cvt_pk_bf16_f32 v195, v213, v214
v_lshlrev_b32 v213, 16, v196
v_and_b32 v214, 0xffff0000, v196
v_sub_f32 v213, v213, v212
v_sub_f32 v214, v214, v212
v_cvt_pk_bf16_f32 v196, v213, v214
v_lshlrev_b32 v213, 16, v197
v_and_b32 v214, 0xffff0000, v197
v_sub_f32 v213, v213, v212
v_sub_f32 v214, v214, v212
v_cvt_pk_bf16_f32 v197, v213, v214
v_lshlrev_b32 v213, 16, v198
v_and_b32 v214, 0xffff0000, v198
v_sub_f32 v213, v213, v212
v_sub_f32 v214, v214, v212
v_cvt_pk_bf16_f32 v198, v213, v214
v_lshlrev_b32 v213, 16, v199
v_and_b32 v214, 0xffff0000, v199
v_sub_f32 v213, v213, v212
v_sub_f32 v214, v214, v212
v_cvt_pk_bf16_f32 v199, v213, v214
v_lshlrev_b32 v213, 16, v200
v_and_b32 v214, 0xffff0000, v200
v_sub_f32 v213, v213, v212
v_sub_f32 v214, v214, v212
v_cvt_pk_bf16_f32 v200, v213, v214
v_lshlrev_b32 v213, 16, v201
v_and_b32 v214, 0xffff0000, v201
v_sub_f32 v213, v213, v212
v_sub_f32 v214, v214, v212
v_cvt_pk_bf16_f32 v201, v213, v214
v_lshlrev_b32 v213, 16, v202
v_and_b32 v214, 0xffff0000, v202
v_sub_f32 v213, v213, v212
v_sub_f32 v214, v214, v212
v_cvt_pk_bf16_f32 v202, v213, v214
v_lshlrev_b32 v213, 16, v203
v_and_b32 v214, 0xffff0000, v203
v_sub_f32 v213, v213, v212
v_sub_f32 v214, v214, v212
v_cvt_pk_bf16_f32 v203, v213, v214
v_lshlrev_b32 v213, 16, v204
v_and_b32 v214, 0xffff0000, v204
v_sub_f32 v213, v213, v212
v_sub_f32 v214, v214, v212
v_cvt_pk_bf16_f32 v204, v213, v214
v_lshlrev_b32 v213, 16, v205
v_and_b32 v214, 0xffff0000, v205
v_sub_f32 v213, v213, v212
v_sub_f32 v214, v214, v212
v_cvt_pk_bf16_f32 v205, v213, v214
v_lshlrev_b32 v213, 16, v206
v_and_b32 v214, 0xffff0000, v206
v_sub_f32 v213, v213, v212
v_sub_f32 v214, v214, v212
v_cvt_pk_bf16_f32 v206, v213, v214
v_lshlrev_b32 v213, 16, v207
v_and_b32 v214, 0xffff0000, v207
v_sub_f32 v213, v213, v212
v_sub_f32 v214, v214, v212
v_cvt_pk_bf16_f32 v207, v213, v214
PR_store:
buffer_store_dwordx4 v[184:187], v219, s[20:23], s44 offen offset:0 sc1
buffer_store_dwordx4 v[188:191], v219, s[20:23], s44 offen offset:128 sc1
buffer_store_dwordx4 v[192:195], v219, s[20:23], s44 offen offset:256 sc1
buffer_store_dwordx4 v[196:199], v219, s[20:23], s44 offen offset:3072 sc1
buffer_store_dwordx4 v[200:203], v219, s[20:23], s44 offen offset:3200 sc1
buffer_store_dwordx4 v[204:207], v219, s[20:23], s44 offen offset:3328 sc1
s_branch C_pro2
M_end:
s_endpgm
.section .rodata,"a"
.p2align 6
.amdhsa_kernel standalone__detection_seg_mask2former__vision_kernel
  .amdhsa_next_free_vgpr 256
  .amdhsa_next_free_sgpr 102
  .amdhsa_accum_offset 256
  .amdhsa_group_segment_fixed_size 0
  .amdhsa_kernarg_size 96
  .amdhsa_user_sgpr_count 2
  .amdhsa_user_sgpr_kernarg_segment_ptr 1
  .amdhsa_system_sgpr_workgroup_id_x 1
  .amdhsa_float_denorm_mode_32 3
.end_amdhsa_kernel
```
